```python
import torch

def _softmax(x, axis=-1):
    return torch.softmax(x, dim=axis)

def _gelu(x):
    return torch.nn.functional.gelu(x, approximate='tanh')

def _silu(x):
    return torch.nn.functional.silu(x)

def _sigmoid(x):
    return torch.sigmoid(x)

def _layernorm(x, axis=-1, eps=1e-05):
    m = x.mean(dim=axis, keepdim=True)
    v = x.var(dim=axis, keepdim=True, unbiased=False)
    return (x - m) / torch.sqrt(v + eps)

def _scatter_add(tgt, idx, src, axis=0):
    return tgt.clone().index_add_(axis, idx, src)

def _segment_sum(src, seg, n):
    out = torch.zeros((n,) + src.shape[1:], dtype=src.dtype)
    return out.index_add_(0, seg, src)

def _pad(x, pw):
    flat = tuple((v for pair in reversed(pw) for v in pair))
    return torch.nn.functional.pad(x, flat)
kernel_name = 'adaLN_cond__mha_block_cached__glu_gated_glu__decode'

def setup_inputs():

    _w = lambda a: (lambda t: t.to(torch.bfloat16) if t.is_floating_point() else t)(torch.as_tensor(a))

    def _A_setup():
        B, Sq, D = (2, 1, 448)
        H, Sk, Dh = (16, 8192, 256)
        return {'x': _w((lambda *s: torch.randn(*s, dtype=torch.bfloat16) * 0.05)(B, Sq, D)), 'k_cache': _w((lambda *s: torch.randn(*s, dtype=torch.bfloat16) * 3.2)(B, H, Sk, Dh)), 'v_cache': _w((lambda *s: torch.randn(*s, dtype=torch.bfloat16) * 0.4)(B, H, Sk, Dh)), 'wq': _w((lambda *s: torch.randn(*s, dtype=torch.bfloat16) * 3.2)(D, H * Dh) * D ** (-0.5)), 'wo': _w((lambda *s: torch.randn(*s, dtype=torch.bfloat16) * 0.4)(H * Dh, D) * (H * Dh) ** (-0.5))}
    _A_in = _A_setup()

    def _B_setup():
        B, S, D, F = (2, 1, 448, 1792)
        return {'x': _w((lambda *s: torch.randn(*s, dtype=torch.bfloat16) * 0.05)(B, S, D)), 'w_gate': _w((lambda *s: torch.randn(*s, dtype=torch.bfloat16) * 0.05)(D, F)), 'w_up': _w((lambda *s: torch.randn(*s, dtype=torch.bfloat16) * 0.05)(D, F)), 'w_down': _w((lambda *s: torch.randn(*s, dtype=torch.bfloat16) * 0.05)(F, D))}
    _B_in = _B_setup()
    return {'A_x': _A_in['x'], 'A_k_cache': _A_in['k_cache'], 'A_v_cache': _A_in['v_cache'], 'A_wq': _A_in['wq'], 'A_wo': _A_in['wo'], 'B_x': _B_in['x'], 'B_w_gate': _B_in['w_gate'], 'B_w_up': _B_in['w_up'], 'B_w_down': _B_in['w_down'], 'c': _w((lambda *s: torch.randn(*s, dtype=torch.bfloat16) * 0.1)(2, 448) * 8.0), 'w_mod': _w((lambda *s: torch.randn(*s, dtype=torch.bfloat16) * 0.1)(448, 6 * 448) * 448 ** (-0.5) * 8.0)}

def reference(A_x, A_k_cache, A_v_cache, A_wq, A_wo, B_x, B_w_gate, B_w_up, B_w_down, c, w_mod):

    def _A_ref(x, k_cache, v_cache, wq, wo):
        B, Sq, D = x.shape
        H, Dh = (16, 256)
        q = (lambda x, *d: x.permute(*d))((x @ wq).reshape(B, Sq, H, Dh), 0, 2, 1, 3)
        scores = torch.einsum('bhqd,bhkd->bhqk', q, k_cache) * Dh ** (-0.5)
        p = _softmax(scores, axis=-1)
        o = torch.einsum('bhqk,bhkd->bhqd', p, v_cache)
        return (lambda x, *d: x.permute(*d))(o, 0, 2, 1, 3).reshape(B, Sq, H * Dh) @ wo

    def _B_ref(x, w_gate, w_up, w_down):
        g = torch.einsum('bsd,df->bsf', x, w_gate)
        u = torch.einsum('bsd,df->bsf', x, w_up)
        h = _sigmoid(g) * u
        return torch.einsum('bsf,fd->bsd', h, w_down)
    x = A_x
    mod = (_silu(c) @ w_mod).reshape(c.shape[0], 6, 1, -1)
    sa, ca, ga, sb, cb, gb = (mod[:, 0].clone(), mod[:, 1].clone(), mod[:, 2].clone(), mod[:, 3].clone(), mod[:, 4].clone(), mod[:, 5].clone())
    h = _layernorm(x, axis=-1) * (1 + ca) + sa
    x = x + ga * _A_ref(h, A_k_cache, A_v_cache, A_wq, A_wo)
    h = _layernorm(x, axis=-1) * (1 + cb) + sb
    x = x + gb * _B_ref(h, B_w_gate, B_w_up, B_w_down)
    return x
```

```asm
; @launch grid=(256,1,1) block=(256,1,1) lds=38144
.amdgcn_target "amdgcn-amd-amdhsa--gfx950"
.text
.globl adaLN_cond__mha_block_cached__glu_gated_glu__decode_kernel
.p2align 8
.type adaLN_cond__mha_block_cached__glu_gated_glu__decode_kernel,@function
adaLN_cond__mha_block_cached__glu_gated_glu__decode_kernel:
    s_cmp_ge_u32 s2, 256
    s_cbranch_scc1 L_exit
    s_cmp_lt_u32 s2, 192
    s_cbranch_scc0 L_helper0
    s_load_dwordx2 s[18:19], s[0:1], 8
    s_load_dwordx2 s[20:21], s[0:1], 16
    s_load_dwordx4 s[40:43], s[0:1], 96
    v_lshlrev_b32 v3, 7, v0
    s_getpc_b64 s[46:47]
L_pc_1:
    s_sub_u32 s46, s46, L_pc_1-adaLN_cond__mha_block_cached__glu_gated_glu__decode_kernel
    s_subb_u32 s47, s47, 0
    s_mov_b32 s6, L_codeend-adaLN_cond__mha_block_cached__glu_gated_glu__decode_kernel
    v_cmp_gt_u32 vcc, s6, v3
    s_nop 0
    s_and_b64 exec, exec, vcc
    s_cbranch_execz L_nopf_2
    global_load_dword v31, v3, s[46:47]
L_nopf_2:
    s_mov_b64 exec, -1
    v_lshrrev_b32 v1, 6, v0
    v_and_b32 v0, 63, v0
    s_nop 0
    v_readfirstlane_b32 s3, v1
    s_nop 2
L_stream:
    s_mul_hi_u32 s5, s2, 0x2aaaaaab
    s_mul_i32 s6, s5, 6
    s_sub_u32 s6, s2, s6
    s_lshl_b32 s7, s6, 10
    s_mul_hi_u32 s74, s7, 0x55555556
    s_add_u32 s7, s7, 1024
    s_mul_hi_u32 s75, s7, 0x55555556
    s_sub_u32 s75, s75, s74
    s_lshl_b32 s76, s5, 22
    s_lshl_b32 s77, s74, 11
    s_add_u32 s76, s76, s77
    s_lshl_b32 s77, s75, 11
    s_mov_b32 s78, s5
    v_lshrrev_b32 v88, 2, v0
    v_and_b32 v88, 3, v88
    v_lshlrev_b32 v1, 9, v88
    v_lshrrev_b32 v89, 4, v0
    v_lshl_add_u32 v1, v89, 6, v1
    v_and_b32 v90, 3, v0
    v_lshl_add_u32 v1, v90, 4, v1
    s_lshl_b32 s6, s3, 13
    v_add_u32 v1, s6, v1
    s_waitcnt lgkmcnt(0)
    s_add_u32 s8, s18, s76
    s_addc_u32 s9, s19, 0
    s_mov_b32 s10, s77
    s_mov_b32 s11, 0x20000
    s_mov_b32 s56, 0
    s_mov_b32 s57, 4096
    buffer_load_dwordx4 a[0:3], v1, s[8:11], s56 offen offset:0 nt
    buffer_load_dwordx4 a[4:7], v1, s[8:11], s56 offen offset:256 nt
    buffer_load_dwordx4 a[8:11], v1, s[8:11], s56 offen offset:2048 nt
    buffer_load_dwordx4 a[12:15], v1, s[8:11], s56 offen offset:2304 nt
    buffer_load_dwordx4 a[16:19], v1, s[8:11], s57 offen offset:0 nt
    buffer_load_dwordx4 a[20:23], v1, s[8:11], s57 offen offset:256 nt
    buffer_load_dwordx4 a[24:27], v1, s[8:11], s57 offen offset:2048 nt
    buffer_load_dwordx4 a[28:31], v1, s[8:11], s57 offen offset:2304 nt
    s_mov_b32 s56, 32768
    s_mov_b32 s57, 36864
    buffer_load_dwordx4 a[32:35], v1, s[8:11], s56 offen offset:0 nt
    buffer_load_dwordx4 a[36:39], v1, s[8:11], s56 offen offset:256 nt
    buffer_load_dwordx4 a[40:43], v1, s[8:11], s56 offen offset:2048 nt
    buffer_load_dwordx4 a[44:47], v1, s[8:11], s56 offen offset:2304 nt
    buffer_load_dwordx4 a[48:51], v1, s[8:11], s57 offen offset:0 nt
    buffer_load_dwordx4 a[52:55], v1, s[8:11], s57 offen offset:256 nt
    buffer_load_dwordx4 a[56:59], v1, s[8:11], s57 offen offset:2048 nt
    buffer_load_dwordx4 a[60:63], v1, s[8:11], s57 offen offset:2304 nt
    s_mov_b32 s52, s42
    s_mov_b32 s53, s43
    s_mov_b32 s54, 2097152
    s_mov_b32 s55, 0x20000
    v_mov_b32 v92, 0
    buffer_load_dword v7, v92, s[52:55], 0 offen sc1
    s_add_u32 s12, s20, s76
    s_addc_u32 s13, s21, 0
    s_mov_b32 s14, s77
    s_mov_b32 s15, 0x20000
    s_sub_u32 s5, s75, 336
    s_add_u32 s6, s5, 3
    s_sub_u32 s6, s6, s3
    s_lshr_b32 s6, s6, 2
    s_sub_u32 s5, s5, 4
    s_min_u32 s5, s5, s3
    s_add_u32 s5, s5, s3
    s_lshl_b32 s5, s5, 11
    s_lshl_b32 s7, s3, 13
    s_sub_u32 s5, s5, s7
    s_add_u32 s83, s5, 688128
    s_cmp_eq_u32 s6, 2
    s_cselect_b64 s[84:85], -1, 0
    v_lshrrev_b32 v88, 2, v0
    v_and_b32 v88, 3, v88
    v_cmp_gt_u32 vcc, s6, v88
    v_mov_b32 v89, 0xff800000
    v_lshrrev_b32 v90, 4, v0
    v_cndmask_b32 v113, v89, 0, vcc
    v_lshlrev_b32 v2, 9, v90
    v_and_b32 v91, 15, v0
    v_lshl_add_u32 v2, v91, 4, v2
    s_lshl_b32 s6, s3, 13
    v_add_u32 v2, s6, v2
    v_and_b32 v88, 7, v0
    v_lshrrev_b32 v89, 1, v88
    v_and_b32 v90, 1, v0
    v_mov_b32 v91, 0xffff
    v_mov_b32 v92, 0xffff0000
    v_cmp_eq_u32 vcc, 1, v90
    s_nop 1
    v_cndmask_b32 v91, v91, v92, vcc
    v_cmp_eq_u32 vcc, 0, v89
    s_nop 1
    v_cndmask_b32 v3, 0, v91, vcc
    v_cmp_eq_u32 vcc, 1, v89
    s_nop 1
    v_cndmask_b32 v4, 0, v91, vcc
    v_cmp_eq_u32 vcc, 2, v89
    s_nop 1
    v_cndmask_b32 v5, 0, v91, vcc
    v_cmp_eq_u32 vcc, 3, v89
    s_nop 1
    v_cndmask_b32 v6, 0, v91, vcc
    s_mov_b32 s66, 0xf000f
    s_mov_b32 s67, 0xf000f
    s_mov_b32 s68, 0xf000f0
    s_mov_b32 s69, 0xf000f0
    s_mov_b32 s70, 0xf000f00
    s_mov_b32 s71, 0xf000f00
    s_mov_b32 s72, 0xf000f000
    s_mov_b32 s73, 0xf000f000
    v_lshrrev_b32 v88, 4, v0
    v_and_b32 v89, 3, v0
    v_lshl_add_u32 v88, v88, 2, v89
    v_lshlrev_b32 v112, 5, v88
    s_lshr_b32 s5, s78, 4
    s_and_b32 s6, s78, 15
    s_lshl_b32 s5, s5, 14
    s_lshl_b32 s6, s6, 10
    s_add_u32 s80, s5, s6
    s_add_u32 s80, s80, 40960
    s_waitcnt vmcnt(8)
    s_mov_b32 s56, 65536
    s_mov_b32 s57, 69632
    buffer_load_dwordx4 a[64:67], v1, s[8:11], s56 offen offset:0 nt
    buffer_load_dwordx4 a[68:71], v1, s[8:11], s56 offen offset:256 nt
    buffer_load_dwordx4 a[72:75], v1, s[8:11], s56 offen offset:2048 nt
    buffer_load_dwordx4 a[76:79], v1, s[8:11], s56 offen offset:2304 nt
    buffer_load_dwordx4 a[80:83], v1, s[8:11], s57 offen offset:0 nt
    buffer_load_dwordx4 a[84:87], v1, s[8:11], s57 offen offset:256 nt
    buffer_load_dwordx4 a[88:91], v1, s[8:11], s57 offen offset:2048 nt
    buffer_load_dwordx4 a[92:95], v1, s[8:11], s57 offen offset:2304 nt
    s_waitcnt vmcnt(8)
    s_mov_b32 s56, 98304
    s_mov_b32 s57, 102400
    buffer_load_dwordx4 a[96:99], v1, s[8:11], s56 offen offset:0 nt
    buffer_load_dwordx4 a[100:103], v1, s[8:11], s56 offen offset:256 nt
    buffer_load_dwordx4 a[104:107], v1, s[8:11], s56 offen offset:2048 nt
    buffer_load_dwordx4 a[108:111], v1, s[8:11], s56 offen offset:2304 nt
    buffer_load_dwordx4 a[112:115], v1, s[8:11], s57 offen offset:0 nt
    buffer_load_dwordx4 a[116:119], v1, s[8:11], s57 offen offset:256 nt
    buffer_load_dwordx4 a[120:123], v1, s[8:11], s57 offen offset:2048 nt
    buffer_load_dwordx4 a[124:127], v1, s[8:11], s57 offen offset:2304 nt
    s_waitcnt vmcnt(8)
    v_readfirstlane_b32 s44, v7
    s_nop 3
    s_mul_i32 s44, s44, 0x19660d
    s_add_u32 s44, s44, 0x3c6ef35f
    s_mov_b32 s56, 131072
    s_mov_b32 s57, 135168
    buffer_load_dwordx4 a[128:131], v1, s[8:11], s56 offen offset:0 nt
    buffer_load_dwordx4 a[132:135], v1, s[8:11], s56 offen offset:256 nt
    buffer_load_dwordx4 a[136:139], v1, s[8:11], s56 offen offset:2048 nt
    buffer_load_dwordx4 a[140:143], v1, s[8:11], s56 offen offset:2304 nt
    buffer_load_dwordx4 a[144:147], v1, s[8:11], s57 offen offset:0 nt
    buffer_load_dwordx4 a[148:151], v1, s[8:11], s57 offen offset:256 nt
    buffer_load_dwordx4 a[152:155], v1, s[8:11], s57 offen offset:2048 nt
    buffer_load_dwordx4 a[156:159], v1, s[8:11], s57 offen offset:2304 nt
    s_waitcnt vmcnt(8)
    s_mov_b32 s56, 163840
    s_mov_b32 s57, 167936
    buffer_load_dwordx4 a[160:163], v1, s[8:11], s56 offen offset:0 nt
    buffer_load_dwordx4 a[164:167], v1, s[8:11], s56 offen offset:256 nt
    buffer_load_dwordx4 a[168:171], v1, s[8:11], s56 offen offset:2048 nt
    buffer_load_dwordx4 a[172:175], v1, s[8:11], s56 offen offset:2304 nt
    buffer_load_dwordx4 a[176:179], v1, s[8:11], s57 offen offset:0 nt
    buffer_load_dwordx4 a[180:183], v1, s[8:11], s57 offen offset:256 nt
    buffer_load_dwordx4 a[184:187], v1, s[8:11], s57 offen offset:2048 nt
    buffer_load_dwordx4 a[188:191], v1, s[8:11], s57 offen offset:2304 nt
    s_waitcnt vmcnt(8)
    s_mov_b32 s56, 196608
    s_mov_b32 s57, 200704
    buffer_load_dwordx4 a[192:195], v1, s[8:11], s56 offen offset:0 nt
    buffer_load_dwordx4 a[196:199], v1, s[8:11], s56 offen offset:256 nt
    buffer_load_dwordx4 a[200:203], v1, s[8:11], s56 offen offset:2048 nt
    buffer_load_dwordx4 a[204:207], v1, s[8:11], s56 offen offset:2304 nt
    buffer_load_dwordx4 a[208:211], v1, s[8:11], s57 offen offset:0 nt
    buffer_load_dwordx4 a[212:215], v1, s[8:11], s57 offen offset:256 nt
    buffer_load_dwordx4 a[216:219], v1, s[8:11], s57 offen offset:2048 nt
    buffer_load_dwordx4 a[220:223], v1, s[8:11], s57 offen offset:2304 nt
    s_waitcnt vmcnt(8)
    s_mov_b32 s56, 229376
    s_mov_b32 s57, 233472
    buffer_load_dwordx4 a[224:227], v1, s[8:11], s56 offen offset:0 nt
    buffer_load_dwordx4 a[228:231], v1, s[8:11], s56 offen offset:256 nt
    buffer_load_dwordx4 a[232:235], v1, s[8:11], s56 offen offset:2048 nt
    buffer_load_dwordx4 a[236:239], v1, s[8:11], s56 offen offset:2304 nt
    buffer_load_dwordx4 a[240:243], v1, s[8:11], s57 offen offset:0 nt
    buffer_load_dwordx4 a[244:247], v1, s[8:11], s57 offen offset:256 nt
    buffer_load_dwordx4 a[248:251], v1, s[8:11], s57 offen offset:2048 nt
    buffer_load_dwordx4 a[252:255], v1, s[8:11], s57 offen offset:2304 nt
    s_waitcnt vmcnt(8)
    s_mov_b32 s56, 262144
    s_mov_b32 s57, 266240
    buffer_load_dwordx4 v[128:131], v1, s[8:11], s56 offen offset:0 nt
    buffer_load_dwordx4 v[132:135], v1, s[8:11], s56 offen offset:256 nt
    buffer_load_dwordx4 v[136:139], v1, s[8:11], s56 offen offset:2048 nt
    buffer_load_dwordx4 v[140:143], v1, s[8:11], s56 offen offset:2304 nt
    buffer_load_dwordx4 v[144:147], v1, s[8:11], s57 offen offset:0 nt
    buffer_load_dwordx4 v[148:151], v1, s[8:11], s57 offen offset:256 nt
    buffer_load_dwordx4 v[152:155], v1, s[8:11], s57 offen offset:2048 nt
    buffer_load_dwordx4 v[156:159], v1, s[8:11], s57 offen offset:2304 nt
    s_waitcnt vmcnt(8)
    s_mov_b32 s56, 294912
    s_mov_b32 s57, 299008
    buffer_load_dwordx4 v[160:163], v1, s[8:11], s56 offen offset:0 nt
    buffer_load_dwordx4 v[164:167], v1, s[8:11], s56 offen offset:256 nt
    buffer_load_dwordx4 v[168:171], v1, s[8:11], s56 offen offset:2048 nt
    buffer_load_dwordx4 v[172:175], v1, s[8:11], s56 offen offset:2304 nt
    buffer_load_dwordx4 v[176:179], v1, s[8:11], s57 offen offset:0 nt
    buffer_load_dwordx4 v[180:183], v1, s[8:11], s57 offen offset:256 nt
    buffer_load_dwordx4 v[184:187], v1, s[8:11], s57 offen offset:2048 nt
    buffer_load_dwordx4 v[188:191], v1, s[8:11], s57 offen offset:2304 nt
    s_waitcnt vmcnt(8)
    s_mov_b32 s56, 327680
    s_mov_b32 s57, 331776
    buffer_load_dwordx4 v[192:195], v1, s[8:11], s56 offen offset:0 nt
    buffer_load_dwordx4 v[196:199], v1, s[8:11], s56 offen offset:256 nt
    buffer_load_dwordx4 v[200:203], v1, s[8:11], s56 offen offset:2048 nt
    buffer_load_dwordx4 v[204:207], v1, s[8:11], s56 offen offset:2304 nt
    buffer_load_dwordx4 v[208:211], v1, s[8:11], s57 offen offset:0 nt
    buffer_load_dwordx4 v[212:215], v1, s[8:11], s57 offen offset:256 nt
    buffer_load_dwordx4 v[216:219], v1, s[8:11], s57 offen offset:2048 nt
    buffer_load_dwordx4 v[220:223], v1, s[8:11], s57 offen offset:2304 nt
    buffer_load_dwordx4 v[96:99], v112, s[52:55], s80 offen offset:0 sc1
    buffer_load_dwordx4 v[100:103], v112, s[52:55], s80 offen offset:16 sc1
    buffer_load_dwordx4 v[104:107], v112, s[52:55], s80 offen offset:512 sc1
    buffer_load_dwordx4 v[108:111], v112, s[52:55], s80 offen offset:528 sc1
    s_waitcnt vmcnt(8)
    s_mov_b32 s56, 360448
    s_mov_b32 s57, 364544
    buffer_load_dwordx4 v[224:227], v1, s[8:11], s56 offen offset:0 nt
    buffer_load_dwordx4 v[228:231], v1, s[8:11], s56 offen offset:256 nt
    buffer_load_dwordx4 v[232:235], v1, s[8:11], s56 offen offset:2048 nt
    buffer_load_dwordx4 v[236:239], v1, s[8:11], s56 offen offset:2304 nt
    buffer_load_dwordx4 v[240:243], v1, s[8:11], s57 offen offset:0 nt
    buffer_load_dwordx4 v[244:247], v1, s[8:11], s57 offen offset:256 nt
    buffer_load_dwordx4 v[248:251], v1, s[8:11], s57 offen offset:2048 nt
    buffer_load_dwordx4 v[252:255], v1, s[8:11], s57 offen offset:2304 nt
    s_waitcnt vmcnt(8)
    v_xor_b32 v88, s44, v97
    v_xor_b32 v89, s44, v99
    v_or_b32 v88, v88, v89
    v_xor_b32 v89, s44, v101
    v_or_b32 v88, v88, v89
    v_xor_b32 v89, s44, v103
    v_or_b32 v88, v88, v89
    v_xor_b32 v89, s44, v105
    v_or_b32 v88, v88, v89
    v_xor_b32 v89, s44, v107
    v_or_b32 v88, v88, v89
    v_xor_b32 v89, s44, v109
    v_or_b32 v88, v88, v89
    v_xor_b32 v89, s44, v111
    v_or_b32 v88, v88, v89
    v_cmp_ne_u32 vcc, 0, v88
    s_nop 1
    s_cbranch_vccz L_qok_3
    s_mov_b32 s45, 0
L_poll_4:
    buffer_load_dwordx4 v[96:99], v112, s[52:55], s80 offen offset:0 sc1
    buffer_load_dwordx4 v[100:103], v112, s[52:55], s80 offen offset:16 sc1
    buffer_load_dwordx4 v[104:107], v112, s[52:55], s80 offen offset:512 sc1
    buffer_load_dwordx4 v[108:111], v112, s[52:55], s80 offen offset:528 sc1
    s_waitcnt vmcnt(0)
    v_xor_b32 v88, s44, v97
    v_xor_b32 v89, s44, v99
    v_or_b32 v88, v88, v89
    v_xor_b32 v89, s44, v101
    v_or_b32 v88, v88, v89
    v_xor_b32 v89, s44, v103
    v_or_b32 v88, v88, v89
    v_xor_b32 v89, s44, v105
    v_or_b32 v88, v88, v89
    v_xor_b32 v89, s44, v107
    v_or_b32 v88, v88, v89
    v_xor_b32 v89, s44, v109
    v_or_b32 v88, v88, v89
    v_xor_b32 v89, s44, v111
    v_or_b32 v88, v88, v89
    v_cmp_ne_u32 vcc, 0, v88
    s_nop 1
    s_cbranch_vccz L_pollok_5
    s_sleep 2
    s_add_u32 s45, s45, 1
    s_cmp_lt_u32 s45, 200000
    s_cbranch_scc1 L_poll_4
L_pollok_5:
L_qok_3:
    v_cndmask_b32 v8, 0, v96, s[66:67]
    v_cndmask_b32 v9, 0, v98, s[66:67]
    v_cndmask_b32 v10, 0, v100, s[66:67]
    v_cndmask_b32 v11, 0, v102, s[66:67]
    v_cndmask_b32 v12, 0, v104, s[66:67]
    v_cndmask_b32 v13, 0, v106, s[66:67]
    v_cndmask_b32 v14, 0, v108, s[66:67]
    v_cndmask_b32 v15, 0, v110, s[66:67]
    v_cndmask_b32 v16, 0, v96, s[68:69]
    v_cndmask_b32 v17, 0, v98, s[68:69]
    v_cndmask_b32 v18, 0, v100, s[68:69]
    v_cndmask_b32 v19, 0, v102, s[68:69]
    v_cndmask_b32 v20, 0, v104, s[68:69]
    v_cndmask_b32 v21, 0, v106, s[68:69]
    v_cndmask_b32 v22, 0, v108, s[68:69]
    v_cndmask_b32 v23, 0, v110, s[68:69]
    v_cndmask_b32 v24, 0, v96, s[70:71]
    v_cndmask_b32 v25, 0, v98, s[70:71]
    v_cndmask_b32 v26, 0, v100, s[70:71]
    v_cndmask_b32 v27, 0, v102, s[70:71]
    v_cndmask_b32 v28, 0, v104, s[70:71]
    v_cndmask_b32 v29, 0, v106, s[70:71]
    v_cndmask_b32 v30, 0, v108, s[70:71]
    v_cndmask_b32 v31, 0, v110, s[70:71]
    v_cndmask_b32 v32, 0, v96, s[72:73]
    v_cndmask_b32 v33, 0, v98, s[72:73]
    v_cndmask_b32 v34, 0, v100, s[72:73]
    v_cndmask_b32 v35, 0, v102, s[72:73]
    v_cndmask_b32 v36, 0, v104, s[72:73]
    v_cndmask_b32 v37, 0, v106, s[72:73]
    v_cndmask_b32 v38, 0, v108, s[72:73]
    v_cndmask_b32 v39, 0, v110, s[72:73]
    v_mov_b32 v62, 0xff800000
    s_nop 1
    s_waitcnt vmcnt(63)
    v_mfma_f32_16x16x32_bf16 v[64:67], a[0:3], v[8:11], 0
    v_mfma_f32_16x16x32_bf16 v[64:67], a[4:7], v[12:15], v[64:67]
    v_mfma_f32_16x16x32_bf16 v[64:67], a[8:11], v[16:19], v[64:67]
    v_mfma_f32_16x16x32_bf16 v[64:67], a[12:15], v[20:23], v[64:67]
    v_mfma_f32_16x16x32_bf16 v[64:67], a[16:19], v[24:27], v[64:67]
    v_mfma_f32_16x16x32_bf16 v[64:67], a[20:23], v[28:31], v[64:67]
    v_mfma_f32_16x16x32_bf16 v[64:67], a[24:27], v[32:35], v[64:67]
    v_mfma_f32_16x16x32_bf16 v[64:67], a[28:31], v[36:39], v[64:67]
    s_nop 7
    v_mov_b32_dpp v40, v64 quad_perm:[0,0,0,0] row_mask:0xf bank_mask:0xf
    v_mov_b32_dpp v89, v65 quad_perm:[1,1,1,1] row_mask:0xf bank_mask:0xf
    s_nop 0
    v_add_f32_dpp v40, v66, v40 quad_perm:[2,2,2,2] row_mask:0xf bank_mask:0xf
    v_add_f32_dpp v89, v67, v89 quad_perm:[3,3,3,3] row_mask:0xf bank_mask:0xf
    v_add_f32 v40, v40, v89
    v_cvt_pk_bf16_f32 v88, v40, v40
    v_lshlrev_b32 v40, 16, v88
    v_max_f32 v62, v62, v40
    s_waitcnt vmcnt(63)
    v_mfma_f32_16x16x32_bf16 v[68:71], a[32:35], v[8:11], 0
    v_mfma_f32_16x16x32_bf16 v[68:71], a[36:39], v[12:15], v[68:71]
    v_mfma_f32_16x16x32_bf16 v[68:71], a[40:43], v[16:19], v[68:71]
    v_mfma_f32_16x16x32_bf16 v[68:71], a[44:47], v[20:23], v[68:71]
    v_mfma_f32_16x16x32_bf16 v[68:71], a[48:51], v[24:27], v[68:71]
    v_mfma_f32_16x16x32_bf16 v[68:71], a[52:55], v[28:31], v[68:71]
    v_mfma_f32_16x16x32_bf16 v[68:71], a[56:59], v[32:35], v[68:71]
    v_mfma_f32_16x16x32_bf16 v[68:71], a[60:63], v[36:39], v[68:71]
    s_waitcnt vmcnt(24)
    s_mov_b32 s56, 393216
    s_mov_b32 s57, 397312
    buffer_load_dwordx4 a[0:3], v1, s[8:11], s56 offen offset:0 nt
    buffer_load_dwordx4 a[4:7], v1, s[8:11], s56 offen offset:256 nt
    buffer_load_dwordx4 a[8:11], v1, s[8:11], s56 offen offset:2048 nt
    buffer_load_dwordx4 a[12:15], v1, s[8:11], s56 offen offset:2304 nt
    buffer_load_dwordx4 a[16:19], v1, s[8:11], s57 offen offset:0 nt
    buffer_load_dwordx4 a[20:23], v1, s[8:11], s57 offen offset:256 nt
    buffer_load_dwordx4 a[24:27], v1, s[8:11], s57 offen offset:2048 nt
    buffer_load_dwordx4 a[28:31], v1, s[8:11], s57 offen offset:2304 nt
    v_mov_b32_dpp v41, v68 quad_perm:[0,0,0,0] row_mask:0xf bank_mask:0xf
    v_mov_b32_dpp v89, v69 quad_perm:[1,1,1,1] row_mask:0xf bank_mask:0xf
    s_nop 0
    v_add_f32_dpp v41, v70, v41 quad_perm:[2,2,2,2] row_mask:0xf bank_mask:0xf
    v_add_f32_dpp v89, v71, v89 quad_perm:[3,3,3,3] row_mask:0xf bank_mask:0xf
    v_add_f32 v41, v41, v89
    v_cvt_pk_bf16_f32 v88, v41, v41
    v_lshlrev_b32 v41, 16, v88
    v_max_f32 v62, v62, v41
    s_waitcnt vmcnt(63)
    v_mfma_f32_16x16x32_bf16 v[64:67], a[64:67], v[8:11], 0
    v_mfma_f32_16x16x32_bf16 v[64:67], a[68:71], v[12:15], v[64:67]
    v_mfma_f32_16x16x32_bf16 v[64:67], a[72:75], v[16:19], v[64:67]
    v_mfma_f32_16x16x32_bf16 v[64:67], a[76:79], v[20:23], v[64:67]
    v_mfma_f32_16x16x32_bf16 v[64:67], a[80:83], v[24:27], v[64:67]
    v_mfma_f32_16x16x32_bf16 v[64:67], a[84:87], v[28:31], v[64:67]
    v_mfma_f32_16x16x32_bf16 v[64:67], a[88:91], v[32:35], v[64:67]
    v_mfma_f32_16x16x32_bf16 v[64:67], a[92:95], v[36:39], v[64:67]
    s_nop 7
    v_mov_b32_dpp v42, v64 quad_perm:[0,0,0,0] row_mask:0xf bank_mask:0xf
    v_mov_b32_dpp v89, v65 quad_perm:[1,1,1,1] row_mask:0xf bank_mask:0xf
    s_nop 0
    v_add_f32_dpp v42, v66, v42 quad_perm:[2,2,2,2] row_mask:0xf bank_mask:0xf
    v_add_f32_dpp v89, v67, v89 quad_perm:[3,3,3,3] row_mask:0xf bank_mask:0xf
    v_add_f32 v42, v42, v89
    v_cvt_pk_bf16_f32 v88, v42, v42
    v_lshlrev_b32 v42, 16, v88
    v_max_f32 v62, v62, v42
    s_waitcnt vmcnt(63)
    v_mfma_f32_16x16x32_bf16 v[68:71], a[96:99], v[8:11], 0
    v_mfma_f32_16x16x32_bf16 v[68:71], a[100:103], v[12:15], v[68:71]
    v_mfma_f32_16x16x32_bf16 v[68:71], a[104:107], v[16:19], v[68:71]
    v_mfma_f32_16x16x32_bf16 v[68:71], a[108:111], v[20:23], v[68:71]
    v_mfma_f32_16x16x32_bf16 v[68:71], a[112:115], v[24:27], v[68:71]
    v_mfma_f32_16x16x32_bf16 v[68:71], a[116:119], v[28:31], v[68:71]
    v_mfma_f32_16x16x32_bf16 v[68:71], a[120:123], v[32:35], v[68:71]
    v_mfma_f32_16x16x32_bf16 v[68:71], a[124:127], v[36:39], v[68:71]
    s_waitcnt vmcnt(24)
    s_mov_b32 s56, 425984
    s_mov_b32 s57, 430080
    buffer_load_dwordx4 a[32:35], v1, s[8:11], s56 offen offset:0 nt
    buffer_load_dwordx4 a[36:39], v1, s[8:11], s56 offen offset:256 nt
    buffer_load_dwordx4 a[40:43], v1, s[8:11], s56 offen offset:2048 nt
    buffer_load_dwordx4 a[44:47], v1, s[8:11], s56 offen offset:2304 nt
    buffer_load_dwordx4 a[48:51], v1, s[8:11], s57 offen offset:0 nt
    buffer_load_dwordx4 a[52:55], v1, s[8:11], s57 offen offset:256 nt
    buffer_load_dwordx4 a[56:59], v1, s[8:11], s57 offen offset:2048 nt
    buffer_load_dwordx4 a[60:63], v1, s[8:11], s57 offen offset:2304 nt
    v_mov_b32_dpp v43, v68 quad_perm:[0,0,0,0] row_mask:0xf bank_mask:0xf
    v_mov_b32_dpp v89, v69 quad_perm:[1,1,1,1] row_mask:0xf bank_mask:0xf
    s_nop 0
    v_add_f32_dpp v43, v70, v43 quad_perm:[2,2,2,2] row_mask:0xf bank_mask:0xf
    v_add_f32_dpp v89, v71, v89 quad_perm:[3,3,3,3] row_mask:0xf bank_mask:0xf
    v_add_f32 v43, v43, v89
    v_cvt_pk_bf16_f32 v88, v43, v43
    v_lshlrev_b32 v43, 16, v88
    v_max_f32 v62, v62, v43
    s_waitcnt vmcnt(63)
    v_mfma_f32_16x16x32_bf16 v[64:67], a[128:131], v[8:11], 0
    v_mfma_f32_16x16x32_bf16 v[64:67], a[132:135], v[12:15], v[64:67]
    v_mfma_f32_16x16x32_bf16 v[64:67], a[136:139], v[16:19], v[64:67]
    v_mfma_f32_16x16x32_bf16 v[64:67], a[140:143], v[20:23], v[64:67]
    v_mfma_f32_16x16x32_bf16 v[64:67], a[144:147], v[24:27], v[64:67]
    v_mfma_f32_16x16x32_bf16 v[64:67], a[148:151], v[28:31], v[64:67]
    v_mfma_f32_16x16x32_bf16 v[64:67], a[152:155], v[32:35], v[64:67]
    v_mfma_f32_16x16x32_bf16 v[64:67], a[156:159], v[36:39], v[64:67]
    s_nop 7
    v_mov_b32_dpp v44, v64 quad_perm:[0,0,0,0] row_mask:0xf bank_mask:0xf
    v_mov_b32_dpp v89, v65 quad_perm:[1,1,1,1] row_mask:0xf bank_mask:0xf
    s_nop 0
    v_add_f32_dpp v44, v66, v44 quad_perm:[2,2,2,2] row_mask:0xf bank_mask:0xf
    v_add_f32_dpp v89, v67, v89 quad_perm:[3,3,3,3] row_mask:0xf bank_mask:0xf
    v_add_f32 v44, v44, v89
    v_cvt_pk_bf16_f32 v88, v44, v44
    v_lshlrev_b32 v44, 16, v88
    v_max_f32 v62, v62, v44
    s_waitcnt vmcnt(63)
    v_mfma_f32_16x16x32_bf16 v[68:71], a[160:163], v[8:11], 0
    v_mfma_f32_16x16x32_bf16 v[68:71], a[164:167], v[12:15], v[68:71]
    v_mfma_f32_16x16x32_bf16 v[68:71], a[168:171], v[16:19], v[68:71]
    v_mfma_f32_16x16x32_bf16 v[68:71], a[172:175], v[20:23], v[68:71]
    v_mfma_f32_16x16x32_bf16 v[68:71], a[176:179], v[24:27], v[68:71]
    v_mfma_f32_16x16x32_bf16 v[68:71], a[180:183], v[28:31], v[68:71]
    v_mfma_f32_16x16x32_bf16 v[68:71], a[184:187], v[32:35], v[68:71]
    v_mfma_f32_16x16x32_bf16 v[68:71], a[188:191], v[36:39], v[68:71]
    s_waitcnt vmcnt(24)
    s_mov_b32 s56, 458752
    s_mov_b32 s57, 462848
    buffer_load_dwordx4 a[64:67], v1, s[8:11], s56 offen offset:0 nt
    buffer_load_dwordx4 a[68:71], v1, s[8:11], s56 offen offset:256 nt
    buffer_load_dwordx4 a[72:75], v1, s[8:11], s56 offen offset:2048 nt
    buffer_load_dwordx4 a[76:79], v1, s[8:11], s56 offen offset:2304 nt
    buffer_load_dwordx4 a[80:83], v1, s[8:11], s57 offen offset:0 nt
    buffer_load_dwordx4 a[84:87], v1, s[8:11], s57 offen offset:256 nt
    buffer_load_dwordx4 a[88:91], v1, s[8:11], s57 offen offset:2048 nt
    buffer_load_dwordx4 a[92:95], v1, s[8:11], s57 offen offset:2304 nt
    v_mov_b32_dpp v45, v68 quad_perm:[0,0,0,0] row_mask:0xf bank_mask:0xf
    v_mov_b32_dpp v89, v69 quad_perm:[1,1,1,1] row_mask:0xf bank_mask:0xf
    s_nop 0
    v_add_f32_dpp v45, v70, v45 quad_perm:[2,2,2,2] row_mask:0xf bank_mask:0xf
    v_add_f32_dpp v89, v71, v89 quad_perm:[3,3,3,3] row_mask:0xf bank_mask:0xf
    v_add_f32 v45, v45, v89
    v_cvt_pk_bf16_f32 v88, v45, v45
    v_lshlrev_b32 v45, 16, v88
    v_max_f32 v62, v62, v45
    s_waitcnt vmcnt(63)
    v_mfma_f32_16x16x32_bf16 v[64:67], a[192:195], v[8:11], 0
    v_mfma_f32_16x16x32_bf16 v[64:67], a[196:199], v[12:15], v[64:67]
    v_mfma_f32_16x16x32_bf16 v[64:67], a[200:203], v[16:19], v[64:67]
    v_mfma_f32_16x16x32_bf16 v[64:67], a[204:207], v[20:23], v[64:67]
    v_mfma_f32_16x16x32_bf16 v[64:67], a[208:211], v[24:27], v[64:67]
    v_mfma_f32_16x16x32_bf16 v[64:67], a[212:215], v[28:31], v[64:67]
    v_mfma_f32_16x16x32_bf16 v[64:67], a[216:219], v[32:35], v[64:67]
    v_mfma_f32_16x16x32_bf16 v[64:67], a[220:223], v[36:39], v[64:67]
    s_nop 7
    v_mov_b32_dpp v46, v64 quad_perm:[0,0,0,0] row_mask:0xf bank_mask:0xf
    v_mov_b32_dpp v89, v65 quad_perm:[1,1,1,1] row_mask:0xf bank_mask:0xf
    s_nop 0
    v_add_f32_dpp v46, v66, v46 quad_perm:[2,2,2,2] row_mask:0xf bank_mask:0xf
    v_add_f32_dpp v89, v67, v89 quad_perm:[3,3,3,3] row_mask:0xf bank_mask:0xf
    v_add_f32 v46, v46, v89
    v_cvt_pk_bf16_f32 v88, v46, v46
    v_lshlrev_b32 v46, 16, v88
    v_max_f32 v62, v62, v46
    s_waitcnt vmcnt(56)
    v_mfma_f32_16x16x32_bf16 v[68:71], a[224:227], v[8:11], 0
    v_mfma_f32_16x16x32_bf16 v[68:71], a[228:231], v[12:15], v[68:71]
    v_mfma_f32_16x16x32_bf16 v[68:71], a[232:235], v[16:19], v[68:71]
    v_mfma_f32_16x16x32_bf16 v[68:71], a[236:239], v[20:23], v[68:71]
    v_mfma_f32_16x16x32_bf16 v[68:71], a[240:243], v[24:27], v[68:71]
    v_mfma_f32_16x16x32_bf16 v[68:71], a[244:247], v[28:31], v[68:71]
    v_mfma_f32_16x16x32_bf16 v[68:71], a[248:251], v[32:35], v[68:71]
    v_mfma_f32_16x16x32_bf16 v[68:71], a[252:255], v[36:39], v[68:71]
    s_waitcnt vmcnt(24)
    s_mov_b32 s56, 491520
    s_mov_b32 s57, 495616
    buffer_load_dwordx4 a[96:99], v1, s[8:11], s56 offen offset:0 nt
    buffer_load_dwordx4 a[100:103], v1, s[8:11], s56 offen offset:256 nt
    buffer_load_dwordx4 a[104:107], v1, s[8:11], s56 offen offset:2048 nt
    buffer_load_dwordx4 a[108:111], v1, s[8:11], s56 offen offset:2304 nt
    buffer_load_dwordx4 a[112:115], v1, s[8:11], s57 offen offset:0 nt
    buffer_load_dwordx4 a[116:119], v1, s[8:11], s57 offen offset:256 nt
    buffer_load_dwordx4 a[120:123], v1, s[8:11], s57 offen offset:2048 nt
    buffer_load_dwordx4 a[124:127], v1, s[8:11], s57 offen offset:2304 nt
    v_mov_b32_dpp v47, v68 quad_perm:[0,0,0,0] row_mask:0xf bank_mask:0xf
    v_mov_b32_dpp v89, v69 quad_perm:[1,1,1,1] row_mask:0xf bank_mask:0xf
    s_nop 0
    v_add_f32_dpp v47, v70, v47 quad_perm:[2,2,2,2] row_mask:0xf bank_mask:0xf
    v_add_f32_dpp v89, v71, v89 quad_perm:[3,3,3,3] row_mask:0xf bank_mask:0xf
    v_add_f32 v47, v47, v89
    v_cvt_pk_bf16_f32 v88, v47, v47
    v_lshlrev_b32 v47, 16, v88
    v_max_f32 v62, v62, v47
    s_waitcnt vmcnt(56)
    v_mfma_f32_16x16x32_bf16 v[64:67], v[128:131], v[8:11], 0
    v_mfma_f32_16x16x32_bf16 v[64:67], v[132:135], v[12:15], v[64:67]
    v_mfma_f32_16x16x32_bf16 v[64:67], v[136:139], v[16:19], v[64:67]
    v_mfma_f32_16x16x32_bf16 v[64:67], v[140:143], v[20:23], v[64:67]
    v_mfma_f32_16x16x32_bf16 v[64:67], v[144:147], v[24:27], v[64:67]
    v_mfma_f32_16x16x32_bf16 v[64:67], v[148:151], v[28:31], v[64:67]
    v_mfma_f32_16x16x32_bf16 v[64:67], v[152:155], v[32:35], v[64:67]
    v_mfma_f32_16x16x32_bf16 v[64:67], v[156:159], v[36:39], v[64:67]
    s_nop 7
    v_mov_b32_dpp v48, v64 quad_perm:[0,0,0,0] row_mask:0xf bank_mask:0xf
    v_mov_b32_dpp v89, v65 quad_perm:[1,1,1,1] row_mask:0xf bank_mask:0xf
    s_nop 0
    v_add_f32_dpp v48, v66, v48 quad_perm:[2,2,2,2] row_mask:0xf bank_mask:0xf
    v_add_f32_dpp v89, v67, v89 quad_perm:[3,3,3,3] row_mask:0xf bank_mask:0xf
    v_add_f32 v48, v48, v89
    v_cvt_pk_bf16_f32 v88, v48, v48
    v_lshlrev_b32 v48, 16, v88
    v_max_f32 v62, v62, v48
    s_waitcnt vmcnt(48)
    v_mfma_f32_16x16x32_bf16 v[68:71], v[160:163], v[8:11], 0
    v_mfma_f32_16x16x32_bf16 v[68:71], v[164:167], v[12:15], v[68:71]
    v_mfma_f32_16x16x32_bf16 v[68:71], v[168:171], v[16:19], v[68:71]
    v_mfma_f32_16x16x32_bf16 v[68:71], v[172:175], v[20:23], v[68:71]
    v_mfma_f32_16x16x32_bf16 v[68:71], v[176:179], v[24:27], v[68:71]
    v_mfma_f32_16x16x32_bf16 v[68:71], v[180:183], v[28:31], v[68:71]
    v_mfma_f32_16x16x32_bf16 v[68:71], v[184:187], v[32:35], v[68:71]
    v_mfma_f32_16x16x32_bf16 v[68:71], v[188:191], v[36:39], v[68:71]
    s_waitcnt vmcnt(24)
    s_mov_b32 s56, 524288
    s_mov_b32 s57, 528384
    buffer_load_dwordx4 a[128:131], v1, s[8:11], s56 offen offset:0 nt
    buffer_load_dwordx4 a[132:135], v1, s[8:11], s56 offen offset:256 nt
    buffer_load_dwordx4 a[136:139], v1, s[8:11], s56 offen offset:2048 nt
    buffer_load_dwordx4 a[140:143], v1, s[8:11], s56 offen offset:2304 nt
    buffer_load_dwordx4 a[144:147], v1, s[8:11], s57 offen offset:0 nt
    buffer_load_dwordx4 a[148:151], v1, s[8:11], s57 offen offset:256 nt
    buffer_load_dwordx4 a[152:155], v1, s[8:11], s57 offen offset:2048 nt
    buffer_load_dwordx4 a[156:159], v1, s[8:11], s57 offen offset:2304 nt
    v_mov_b32_dpp v49, v68 quad_perm:[0,0,0,0] row_mask:0xf bank_mask:0xf
    v_mov_b32_dpp v89, v69 quad_perm:[1,1,1,1] row_mask:0xf bank_mask:0xf
    s_nop 0
    v_add_f32_dpp v49, v70, v49 quad_perm:[2,2,2,2] row_mask:0xf bank_mask:0xf
    v_add_f32_dpp v89, v71, v89 quad_perm:[3,3,3,3] row_mask:0xf bank_mask:0xf
    v_add_f32 v49, v49, v89
    v_cvt_pk_bf16_f32 v88, v49, v49
    v_lshlrev_b32 v49, 16, v88
    v_max_f32 v62, v62, v49
    s_waitcnt vmcnt(48)
    v_mfma_f32_16x16x32_bf16 v[64:67], v[192:195], v[8:11], 0
    v_mfma_f32_16x16x32_bf16 v[64:67], v[196:199], v[12:15], v[64:67]
    v_mfma_f32_16x16x32_bf16 v[64:67], v[200:203], v[16:19], v[64:67]
    v_mfma_f32_16x16x32_bf16 v[64:67], v[204:207], v[20:23], v[64:67]
    v_mfma_f32_16x16x32_bf16 v[64:67], v[208:211], v[24:27], v[64:67]
    v_mfma_f32_16x16x32_bf16 v[64:67], v[212:215], v[28:31], v[64:67]
    v_mfma_f32_16x16x32_bf16 v[64:67], v[216:219], v[32:35], v[64:67]
    v_mfma_f32_16x16x32_bf16 v[64:67], v[220:223], v[36:39], v[64:67]
    s_nop 7
    v_mov_b32_dpp v50, v64 quad_perm:[0,0,0,0] row_mask:0xf bank_mask:0xf
    v_mov_b32_dpp v89, v65 quad_perm:[1,1,1,1] row_mask:0xf bank_mask:0xf
    s_nop 0
    v_add_f32_dpp v50, v66, v50 quad_perm:[2,2,2,2] row_mask:0xf bank_mask:0xf
    v_add_f32_dpp v89, v67, v89 quad_perm:[3,3,3,3] row_mask:0xf bank_mask:0xf
    v_add_f32 v50, v50, v89
    v_cvt_pk_bf16_f32 v88, v50, v50
    v_lshlrev_b32 v50, 16, v88
    v_max_f32 v62, v62, v50
    s_waitcnt vmcnt(40)
    v_mfma_f32_16x16x32_bf16 v[68:71], v[224:227], v[8:11], 0
    v_mfma_f32_16x16x32_bf16 v[68:71], v[228:231], v[12:15], v[68:71]
    v_mfma_f32_16x16x32_bf16 v[68:71], v[232:235], v[16:19], v[68:71]
    v_mfma_f32_16x16x32_bf16 v[68:71], v[236:239], v[20:23], v[68:71]
    v_mfma_f32_16x16x32_bf16 v[68:71], v[240:243], v[24:27], v[68:71]
    v_mfma_f32_16x16x32_bf16 v[68:71], v[244:247], v[28:31], v[68:71]
    v_mfma_f32_16x16x32_bf16 v[68:71], v[248:251], v[32:35], v[68:71]
    v_mfma_f32_16x16x32_bf16 v[68:71], v[252:255], v[36:39], v[68:71]
    s_waitcnt vmcnt(24)
    s_mov_b32 s56, 557056
    s_mov_b32 s57, 561152
    buffer_load_dwordx4 a[160:163], v1, s[8:11], s56 offen offset:0 nt
    buffer_load_dwordx4 a[164:167], v1, s[8:11], s56 offen offset:256 nt
    buffer_load_dwordx4 a[168:171], v1, s[8:11], s56 offen offset:2048 nt
    buffer_load_dwordx4 a[172:175], v1, s[8:11], s56 offen offset:2304 nt
    buffer_load_dwordx4 a[176:179], v1, s[8:11], s57 offen offset:0 nt
    buffer_load_dwordx4 a[180:183], v1, s[8:11], s57 offen offset:256 nt
    buffer_load_dwordx4 a[184:187], v1, s[8:11], s57 offen offset:2048 nt
    buffer_load_dwordx4 a[188:191], v1, s[8:11], s57 offen offset:2304 nt
    v_mov_b32_dpp v51, v68 quad_perm:[0,0,0,0] row_mask:0xf bank_mask:0xf
    v_mov_b32_dpp v89, v69 quad_perm:[1,1,1,1] row_mask:0xf bank_mask:0xf
    s_nop 0
    v_add_f32_dpp v51, v70, v51 quad_perm:[2,2,2,2] row_mask:0xf bank_mask:0xf
    v_add_f32_dpp v89, v71, v89 quad_perm:[3,3,3,3] row_mask:0xf bank_mask:0xf
    v_add_f32 v51, v51, v89
    v_cvt_pk_bf16_f32 v88, v51, v51
    v_lshlrev_b32 v51, 16, v88
    v_max_f32 v62, v62, v51
    s_waitcnt vmcnt(40)
    v_mfma_f32_16x16x32_bf16 v[64:67], a[0:3], v[8:11], 0
    v_mfma_f32_16x16x32_bf16 v[64:67], a[4:7], v[12:15], v[64:67]
    v_mfma_f32_16x16x32_bf16 v[64:67], a[8:11], v[16:19], v[64:67]
    v_mfma_f32_16x16x32_bf16 v[64:67], a[12:15], v[20:23], v[64:67]
    v_mfma_f32_16x16x32_bf16 v[64:67], a[16:19], v[24:27], v[64:67]
    v_mfma_f32_16x16x32_bf16 v[64:67], a[20:23], v[28:31], v[64:67]
    v_mfma_f32_16x16x32_bf16 v[64:67], a[24:27], v[32:35], v[64:67]
    v_mfma_f32_16x16x32_bf16 v[64:67], a[28:31], v[36:39], v[64:67]
    s_nop 7
    v_mov_b32_dpp v52, v64 quad_perm:[0,0,0,0] row_mask:0xf bank_mask:0xf
    v_mov_b32_dpp v89, v65 quad_perm:[1,1,1,1] row_mask:0xf bank_mask:0xf
    s_nop 0
    v_add_f32_dpp v52, v66, v52 quad_perm:[2,2,2,2] row_mask:0xf bank_mask:0xf
    v_add_f32_dpp v89, v67, v89 quad_perm:[3,3,3,3] row_mask:0xf bank_mask:0xf
    v_add_f32 v52, v52, v89
    v_cvt_pk_bf16_f32 v88, v52, v52
    v_lshlrev_b32 v52, 16, v88
    v_max_f32 v62, v62, v52
    s_waitcnt vmcnt(32)
    v_mfma_f32_16x16x32_bf16 v[68:71], a[32:35], v[8:11], 0
    v_mfma_f32_16x16x32_bf16 v[68:71], a[36:39], v[12:15], v[68:71]
    v_mfma_f32_16x16x32_bf16 v[68:71], a[40:43], v[16:19], v[68:71]
    v_mfma_f32_16x16x32_bf16 v[68:71], a[44:47], v[20:23], v[68:71]
    v_mfma_f32_16x16x32_bf16 v[68:71], a[48:51], v[24:27], v[68:71]
    v_mfma_f32_16x16x32_bf16 v[68:71], a[52:55], v[28:31], v[68:71]
    v_mfma_f32_16x16x32_bf16 v[68:71], a[56:59], v[32:35], v[68:71]
    v_mfma_f32_16x16x32_bf16 v[68:71], a[60:63], v[36:39], v[68:71]
    s_mov_b32 s56, 589824
    s_mov_b32 s57, 593920
    buffer_load_dwordx4 a[192:195], v1, s[8:11], s56 offen offset:0 nt
    buffer_load_dwordx4 a[196:199], v1, s[8:11], s56 offen offset:256 nt
    buffer_load_dwordx4 a[200:203], v1, s[8:11], s56 offen offset:2048 nt
    buffer_load_dwordx4 a[204:207], v1, s[8:11], s56 offen offset:2304 nt
    buffer_load_dwordx4 a[208:211], v1, s[8:11], s57 offen offset:0 nt
    buffer_load_dwordx4 a[212:215], v1, s[8:11], s57 offen offset:256 nt
    buffer_load_dwordx4 a[216:219], v1, s[8:11], s57 offen offset:2048 nt
    buffer_load_dwordx4 a[220:223], v1, s[8:11], s57 offen offset:2304 nt
    v_mov_b32_dpp v53, v68 quad_perm:[0,0,0,0] row_mask:0xf bank_mask:0xf
    v_mov_b32_dpp v89, v69 quad_perm:[1,1,1,1] row_mask:0xf bank_mask:0xf
    s_nop 0
    v_add_f32_dpp v53, v70, v53 quad_perm:[2,2,2,2] row_mask:0xf bank_mask:0xf
    v_add_f32_dpp v89, v71, v89 quad_perm:[3,3,3,3] row_mask:0xf bank_mask:0xf
    v_add_f32 v53, v53, v89
    v_cvt_pk_bf16_f32 v88, v53, v53
    v_lshlrev_b32 v53, 16, v88
    v_max_f32 v62, v62, v53
    s_waitcnt vmcnt(32)
    v_mfma_f32_16x16x32_bf16 v[64:67], a[64:67], v[8:11], 0
    v_mfma_f32_16x16x32_bf16 v[64:67], a[68:71], v[12:15], v[64:67]
    v_mfma_f32_16x16x32_bf16 v[64:67], a[72:75], v[16:19], v[64:67]
    v_mfma_f32_16x16x32_bf16 v[64:67], a[76:79], v[20:23], v[64:67]
    v_mfma_f32_16x16x32_bf16 v[64:67], a[80:83], v[24:27], v[64:67]
    v_mfma_f32_16x16x32_bf16 v[64:67], a[84:87], v[28:31], v[64:67]
    v_mfma_f32_16x16x32_bf16 v[64:67], a[88:91], v[32:35], v[64:67]
    v_mfma_f32_16x16x32_bf16 v[64:67], a[92:95], v[36:39], v[64:67]
    s_nop 7
    v_mov_b32_dpp v54, v64 quad_perm:[0,0,0,0] row_mask:0xf bank_mask:0xf
    v_mov_b32_dpp v89, v65 quad_perm:[1,1,1,1] row_mask:0xf bank_mask:0xf
    s_nop 0
    v_add_f32_dpp v54, v66, v54 quad_perm:[2,2,2,2] row_mask:0xf bank_mask:0xf
    v_add_f32_dpp v89, v67, v89 quad_perm:[3,3,3,3] row_mask:0xf bank_mask:0xf
    v_add_f32 v54, v54, v89
    v_cvt_pk_bf16_f32 v88, v54, v54
    v_lshlrev_b32 v54, 16, v88
    v_max_f32 v62, v62, v54
    s_waitcnt vmcnt(24)
    v_mfma_f32_16x16x32_bf16 v[68:71], a[96:99], v[8:11], 0
    v_mfma_f32_16x16x32_bf16 v[68:71], a[100:103], v[12:15], v[68:71]
    v_mfma_f32_16x16x32_bf16 v[68:71], a[104:107], v[16:19], v[68:71]
    v_mfma_f32_16x16x32_bf16 v[68:71], a[108:111], v[20:23], v[68:71]
    v_mfma_f32_16x16x32_bf16 v[68:71], a[112:115], v[24:27], v[68:71]
    v_mfma_f32_16x16x32_bf16 v[68:71], a[116:119], v[28:31], v[68:71]
    v_mfma_f32_16x16x32_bf16 v[68:71], a[120:123], v[32:35], v[68:71]
    v_mfma_f32_16x16x32_bf16 v[68:71], a[124:127], v[36:39], v[68:71]
    s_mov_b32 s56, 622592
    s_mov_b32 s57, 626688
    buffer_load_dwordx4 a[224:227], v1, s[8:11], s56 offen offset:0 nt
    buffer_load_dwordx4 a[228:231], v1, s[8:11], s56 offen offset:256 nt
    buffer_load_dwordx4 a[232:235], v1, s[8:11], s56 offen offset:2048 nt
    buffer_load_dwordx4 a[236:239], v1, s[8:11], s56 offen offset:2304 nt
    buffer_load_dwordx4 a[240:243], v1, s[8:11], s57 offen offset:0 nt
    buffer_load_dwordx4 a[244:247], v1, s[8:11], s57 offen offset:256 nt
    buffer_load_dwordx4 a[248:251], v1, s[8:11], s57 offen offset:2048 nt
    buffer_load_dwordx4 a[252:255], v1, s[8:11], s57 offen offset:2304 nt
    v_mov_b32_dpp v55, v68 quad_perm:[0,0,0,0] row_mask:0xf bank_mask:0xf
    v_mov_b32_dpp v89, v69 quad_perm:[1,1,1,1] row_mask:0xf bank_mask:0xf
    s_nop 0
    v_add_f32_dpp v55, v70, v55 quad_perm:[2,2,2,2] row_mask:0xf bank_mask:0xf
    v_add_f32_dpp v89, v71, v89 quad_perm:[3,3,3,3] row_mask:0xf bank_mask:0xf
    v_add_f32 v55, v55, v89
    v_cvt_pk_bf16_f32 v88, v55, v55
    v_lshlrev_b32 v55, 16, v88
    v_max_f32 v62, v62, v55
    s_waitcnt vmcnt(24)
    v_mfma_f32_16x16x32_bf16 v[64:67], a[128:131], v[8:11], 0
    v_mfma_f32_16x16x32_bf16 v[64:67], a[132:135], v[12:15], v[64:67]
    v_mfma_f32_16x16x32_bf16 v[64:67], a[136:139], v[16:19], v[64:67]
    v_mfma_f32_16x16x32_bf16 v[64:67], a[140:143], v[20:23], v[64:67]
    v_mfma_f32_16x16x32_bf16 v[64:67], a[144:147], v[24:27], v[64:67]
    v_mfma_f32_16x16x32_bf16 v[64:67], a[148:151], v[28:31], v[64:67]
    v_mfma_f32_16x16x32_bf16 v[64:67], a[152:155], v[32:35], v[64:67]
    v_mfma_f32_16x16x32_bf16 v[64:67], a[156:159], v[36:39], v[64:67]
    s_mov_b32 s56, 655360
    s_mov_b32 s57, 659456
    buffer_load_dwordx4 v[128:131], v1, s[8:11], s56 offen offset:0 nt
    buffer_load_dwordx4 v[132:135], v1, s[8:11], s56 offen offset:256 nt
    buffer_load_dwordx4 v[136:139], v1, s[8:11], s56 offen offset:2048 nt
    buffer_load_dwordx4 v[140:143], v1, s[8:11], s56 offen offset:2304 nt
    buffer_load_dwordx4 v[144:147], v1, s[8:11], s57 offen offset:0 nt
    buffer_load_dwordx4 v[148:151], v1, s[8:11], s57 offen offset:256 nt
    buffer_load_dwordx4 v[152:155], v1, s[8:11], s57 offen offset:2048 nt
    buffer_load_dwordx4 v[156:159], v1, s[8:11], s57 offen offset:2304 nt
    v_mov_b32_dpp v56, v64 quad_perm:[0,0,0,0] row_mask:0xf bank_mask:0xf
    v_mov_b32_dpp v89, v65 quad_perm:[1,1,1,1] row_mask:0xf bank_mask:0xf
    s_nop 0
    v_add_f32_dpp v56, v66, v56 quad_perm:[2,2,2,2] row_mask:0xf bank_mask:0xf
    v_add_f32_dpp v89, v67, v89 quad_perm:[3,3,3,3] row_mask:0xf bank_mask:0xf
    v_add_f32 v56, v56, v89
    v_cvt_pk_bf16_f32 v88, v56, v56
    v_lshlrev_b32 v56, 16, v88
    v_max_f32 v62, v62, v56
    s_waitcnt vmcnt(24)
    v_mfma_f32_16x16x32_bf16 v[68:71], a[160:163], v[8:11], 0
    v_mfma_f32_16x16x32_bf16 v[68:71], a[164:167], v[12:15], v[68:71]
    v_mfma_f32_16x16x32_bf16 v[68:71], a[168:171], v[16:19], v[68:71]
    v_mfma_f32_16x16x32_bf16 v[68:71], a[172:175], v[20:23], v[68:71]
    v_mfma_f32_16x16x32_bf16 v[68:71], a[176:179], v[24:27], v[68:71]
    v_mfma_f32_16x16x32_bf16 v[68:71], a[180:183], v[28:31], v[68:71]
    v_mfma_f32_16x16x32_bf16 v[68:71], a[184:187], v[32:35], v[68:71]
    v_mfma_f32_16x16x32_bf16 v[68:71], a[188:191], v[36:39], v[68:71]
    buffer_load_dwordx4 v[160:163], v1, s[8:11], s83 offen offset:0 nt
    buffer_load_dwordx4 v[164:167], v1, s[8:11], s83 offen offset:256 nt
    s_mov_b64 exec, s[84:85]
    buffer_load_dwordx4 v[168:171], v1, s[8:11], s83 offen offset:2048 nt
    buffer_load_dwordx4 v[172:175], v1, s[8:11], s83 offen offset:2304 nt
    s_mov_b64 exec, -1
    s_nop 1
    v_mov_b32_dpp v57, v68 quad_perm:[0,0,0,0] row_mask:0xf bank_mask:0xf
    v_mov_b32_dpp v89, v69 quad_perm:[1,1,1,1] row_mask:0xf bank_mask:0xf
    s_nop 0
    v_add_f32_dpp v57, v70, v57 quad_perm:[2,2,2,2] row_mask:0xf bank_mask:0xf
    v_add_f32_dpp v89, v71, v89 quad_perm:[3,3,3,3] row_mask:0xf bank_mask:0xf
    v_add_f32 v57, v57, v89
    v_cvt_pk_bf16_f32 v88, v57, v57
    v_lshlrev_b32 v57, 16, v88
    v_max_f32 v62, v62, v57
    s_waitcnt vmcnt(20)
    v_mfma_f32_16x16x32_bf16 v[64:67], a[192:195], v[8:11], 0
    v_mfma_f32_16x16x32_bf16 v[64:67], a[196:199], v[12:15], v[64:67]
    v_mfma_f32_16x16x32_bf16 v[64:67], a[200:203], v[16:19], v[64:67]
    v_mfma_f32_16x16x32_bf16 v[64:67], a[204:207], v[20:23], v[64:67]
    v_mfma_f32_16x16x32_bf16 v[64:67], a[208:211], v[24:27], v[64:67]
    v_mfma_f32_16x16x32_bf16 v[64:67], a[212:215], v[28:31], v[64:67]
    v_mfma_f32_16x16x32_bf16 v[64:67], a[216:219], v[32:35], v[64:67]
    v_mfma_f32_16x16x32_bf16 v[64:67], a[220:223], v[36:39], v[64:67]
    s_mov_b32 s56, 0
    s_mov_b32 s57, 4096
    buffer_load_dwordx4 v[192:195], v2, s[12:15], s56 offen offset:0 nt
    buffer_load_dwordx4 v[196:199], v2, s[12:15], s56 offen offset:256 nt
    buffer_load_dwordx4 v[200:203], v2, s[12:15], s56 offen offset:2048 nt
    buffer_load_dwordx4 v[204:207], v2, s[12:15], s56 offen offset:2304 nt
    buffer_load_dwordx4 v[208:211], v2, s[12:15], s57 offen offset:0 nt
    buffer_load_dwordx4 v[212:215], v2, s[12:15], s57 offen offset:256 nt
    buffer_load_dwordx4 v[216:219], v2, s[12:15], s57 offen offset:2048 nt
    buffer_load_dwordx4 v[220:223], v2, s[12:15], s57 offen offset:2304 nt
    v_mov_b32_dpp v58, v64 quad_perm:[0,0,0,0] row_mask:0xf bank_mask:0xf
    v_mov_b32_dpp v89, v65 quad_perm:[1,1,1,1] row_mask:0xf bank_mask:0xf
    s_nop 0
    v_add_f32_dpp v58, v66, v58 quad_perm:[2,2,2,2] row_mask:0xf bank_mask:0xf
    v_add_f32_dpp v89, v67, v89 quad_perm:[3,3,3,3] row_mask:0xf bank_mask:0xf
    v_add_f32 v58, v58, v89
    v_cvt_pk_bf16_f32 v88, v58, v58
    v_lshlrev_b32 v58, 16, v88
    v_max_f32 v62, v62, v58
    s_waitcnt vmcnt(20)
    v_mfma_f32_16x16x32_bf16 v[68:71], a[224:227], v[8:11], 0
    v_mfma_f32_16x16x32_bf16 v[68:71], a[228:231], v[12:15], v[68:71]
    v_mfma_f32_16x16x32_bf16 v[68:71], a[232:235], v[16:19], v[68:71]
    v_mfma_f32_16x16x32_bf16 v[68:71], a[236:239], v[20:23], v[68:71]
    v_mfma_f32_16x16x32_bf16 v[68:71], a[240:243], v[24:27], v[68:71]
    v_mfma_f32_16x16x32_bf16 v[68:71], a[244:247], v[28:31], v[68:71]
    v_mfma_f32_16x16x32_bf16 v[68:71], a[248:251], v[32:35], v[68:71]
    v_mfma_f32_16x16x32_bf16 v[68:71], a[252:255], v[36:39], v[68:71]
    s_mov_b32 s56, 32768
    s_mov_b32 s57, 36864
    buffer_load_dwordx4 v[224:227], v2, s[12:15], s56 offen offset:0 nt
    buffer_load_dwordx4 v[228:231], v2, s[12:15], s56 offen offset:256 nt
    buffer_load_dwordx4 v[232:235], v2, s[12:15], s56 offen offset:2048 nt
    buffer_load_dwordx4 v[236:239], v2, s[12:15], s56 offen offset:2304 nt
    buffer_load_dwordx4 v[240:243], v2, s[12:15], s57 offen offset:0 nt
    buffer_load_dwordx4 v[244:247], v2, s[12:15], s57 offen offset:256 nt
    buffer_load_dwordx4 v[248:251], v2, s[12:15], s57 offen offset:2048 nt
    buffer_load_dwordx4 v[252:255], v2, s[12:15], s57 offen offset:2304 nt
    v_mov_b32_dpp v59, v68 quad_perm:[0,0,0,0] row_mask:0xf bank_mask:0xf
    v_mov_b32_dpp v89, v69 quad_perm:[1,1,1,1] row_mask:0xf bank_mask:0xf
    s_nop 0
    v_add_f32_dpp v59, v70, v59 quad_perm:[2,2,2,2] row_mask:0xf bank_mask:0xf
    v_add_f32_dpp v89, v71, v89 quad_perm:[3,3,3,3] row_mask:0xf bank_mask:0xf
    v_add_f32 v59, v59, v89
    v_cvt_pk_bf16_f32 v88, v59, v59
    v_lshlrev_b32 v59, 16, v88
    v_max_f32 v62, v62, v59
    s_waitcnt vmcnt(20)
    v_mfma_f32_16x16x32_bf16 v[64:67], v[128:131], v[8:11], 0
    v_mfma_f32_16x16x32_bf16 v[64:67], v[132:135], v[12:15], v[64:67]
    v_mfma_f32_16x16x32_bf16 v[64:67], v[136:139], v[16:19], v[64:67]
    v_mfma_f32_16x16x32_bf16 v[64:67], v[140:143], v[20:23], v[64:67]
    v_mfma_f32_16x16x32_bf16 v[64:67], v[144:147], v[24:27], v[64:67]
    v_mfma_f32_16x16x32_bf16 v[64:67], v[148:151], v[28:31], v[64:67]
    v_mfma_f32_16x16x32_bf16 v[64:67], v[152:155], v[32:35], v[64:67]
    v_mfma_f32_16x16x32_bf16 v[64:67], v[156:159], v[36:39], v[64:67]
    s_mov_b32 s56, 65536
    s_mov_b32 s57, 69632
    buffer_load_dwordx4 a[0:3], v2, s[12:15], s56 offen offset:0 nt
    buffer_load_dwordx4 a[4:7], v2, s[12:15], s56 offen offset:256 nt
    buffer_load_dwordx4 a[8:11], v2, s[12:15], s56 offen offset:2048 nt
    buffer_load_dwordx4 a[12:15], v2, s[12:15], s56 offen offset:2304 nt
    buffer_load_dwordx4 a[16:19], v2, s[12:15], s57 offen offset:0 nt
    buffer_load_dwordx4 a[20:23], v2, s[12:15], s57 offen offset:256 nt
    buffer_load_dwordx4 a[24:27], v2, s[12:15], s57 offen offset:2048 nt
    buffer_load_dwordx4 a[28:31], v2, s[12:15], s57 offen offset:2304 nt
    v_mov_b32_dpp v60, v64 quad_perm:[0,0,0,0] row_mask:0xf bank_mask:0xf
    v_mov_b32_dpp v89, v65 quad_perm:[1,1,1,1] row_mask:0xf bank_mask:0xf
    s_nop 0
    v_add_f32_dpp v60, v66, v60 quad_perm:[2,2,2,2] row_mask:0xf bank_mask:0xf
    v_add_f32_dpp v89, v67, v89 quad_perm:[3,3,3,3] row_mask:0xf bank_mask:0xf
    v_add_f32 v60, v60, v89
    v_cvt_pk_bf16_f32 v88, v60, v60
    v_lshlrev_b32 v60, 16, v88
    v_max_f32 v62, v62, v60
    s_waitcnt vmcnt(24)
    v_mfma_f32_16x16x32_bf16 v[68:71], v[160:163], v[8:11], 0
    v_mfma_f32_16x16x32_bf16 v[68:71], v[164:167], v[12:15], v[68:71]
    v_mfma_f32_16x16x32_bf16 v[68:71], v[168:171], v[16:19], v[68:71]
    v_mfma_f32_16x16x32_bf16 v[68:71], v[172:175], v[20:23], v[68:71]
    s_mov_b32 s56, 98304
    s_mov_b32 s57, 102400
    buffer_load_dwordx4 a[32:35], v2, s[12:15], s56 offen offset:0 nt
    buffer_load_dwordx4 a[36:39], v2, s[12:15], s56 offen offset:256 nt
    buffer_load_dwordx4 a[40:43], v2, s[12:15], s56 offen offset:2048 nt
    buffer_load_dwordx4 a[44:47], v2, s[12:15], s56 offen offset:2304 nt
    buffer_load_dwordx4 a[48:51], v2, s[12:15], s57 offen offset:0 nt
    buffer_load_dwordx4 a[52:55], v2, s[12:15], s57 offen offset:256 nt
    buffer_load_dwordx4 a[56:59], v2, s[12:15], s57 offen offset:2048 nt
    buffer_load_dwordx4 a[60:63], v2, s[12:15], s57 offen offset:2304 nt
    v_mov_b32_dpp v61, v68 quad_perm:[0,0,0,0] row_mask:0xf bank_mask:0xf
    v_mov_b32_dpp v89, v69 quad_perm:[1,1,1,1] row_mask:0xf bank_mask:0xf
    s_nop 0
    v_add_f32_dpp v61, v70, v61 quad_perm:[2,2,2,2] row_mask:0xf bank_mask:0xf
    v_add_f32_dpp v89, v71, v89 quad_perm:[3,3,3,3] row_mask:0xf bank_mask:0xf
    v_add_f32 v61, v61, v89
    v_cvt_pk_bf16_f32 v88, v61, v61
    v_lshlrev_b32 v61, 16, v88
    v_add_f32 v61, v113, v61
    v_max_f32 v62, v62, v61
    s_nop 1
    v_max_f32_dpp v62, v62, v62 row_ror:4 row_mask:0xf bank_mask:0xf
    s_nop 1
    v_max_f32_dpp v62, v62, v62 row_ror:8 row_mask:0xf bank_mask:0xf
    s_nop 1
    v_max_f32_dpp v62, v62, v62 row_bcast:15 row_mask:0xa bank_mask:0xf
    s_nop 1
    v_max_f32_dpp v62, v62, v62 row_bcast:31 row_mask:0xc bank_mask:0xf
    s_nop 1
    v_readlane_b32 s5, v62, 63
    s_mov_b32 s81, 0x3db8aa3b
    s_nop 1
    v_mov_b32 v62, s5
    v_mul_f32 v62, s81, v62
    v_mov_b32 v63, 0
    v_fma_f32 v40, v40, s81, -v62
    v_fma_f32 v41, v41, s81, -v62
    v_fma_f32 v42, v42, s81, -v62
    v_fma_f32 v43, v43, s81, -v62
    v_fma_f32 v44, v44, s81, -v62
    v_fma_f32 v45, v45, s81, -v62
    v_fma_f32 v46, v46, s81, -v62
    v_fma_f32 v47, v47, s81, -v62
    v_fma_f32 v48, v48, s81, -v62
    v_fma_f32 v49, v49, s81, -v62
    v_fma_f32 v50, v50, s81, -v62
    v_fma_f32 v51, v51, s81, -v62
    v_fma_f32 v52, v52, s81, -v62
    v_fma_f32 v53, v53, s81, -v62
    v_fma_f32 v54, v54, s81, -v62
    v_fma_f32 v55, v55, s81, -v62
    v_fma_f32 v56, v56, s81, -v62
    v_fma_f32 v57, v57, s81, -v62
    v_fma_f32 v58, v58, s81, -v62
    v_fma_f32 v59, v59, s81, -v62
    v_fma_f32 v60, v60, s81, -v62
    v_fma_f32 v61, v61, s81, -v62
    v_exp_f32 v40, v40
    v_exp_f32 v41, v41
    v_exp_f32 v42, v42
    v_exp_f32 v43, v43
    v_exp_f32 v44, v44
    v_exp_f32 v45, v45
    v_exp_f32 v46, v46
    v_exp_f32 v47, v47
    v_exp_f32 v48, v48
    v_exp_f32 v49, v49
    v_exp_f32 v50, v50
    v_exp_f32 v51, v51
    v_exp_f32 v52, v52
    v_exp_f32 v53, v53
    v_exp_f32 v54, v54
    v_exp_f32 v55, v55
    v_exp_f32 v56, v56
    v_exp_f32 v57, v57
    v_exp_f32 v58, v58
    v_exp_f32 v59, v59
    v_exp_f32 v60, v60
    v_exp_f32 v61, v61
    s_nop 0
    v_add_f32 v63, v63, v40
    v_cvt_pk_bf16_f32 v40, v40, v40
    v_add_f32 v63, v63, v41
    v_cvt_pk_bf16_f32 v41, v41, v41
    v_add_f32 v63, v63, v42
    v_cvt_pk_bf16_f32 v42, v42, v42
    v_add_f32 v63, v63, v43
    v_cvt_pk_bf16_f32 v43, v43, v43
    v_add_f32 v63, v63, v44
    v_cvt_pk_bf16_f32 v44, v44, v44
    v_add_f32 v63, v63, v45
    v_cvt_pk_bf16_f32 v45, v45, v45
    v_add_f32 v63, v63, v46
    v_cvt_pk_bf16_f32 v46, v46, v46
    v_add_f32 v63, v63, v47
    v_cvt_pk_bf16_f32 v47, v47, v47
    v_add_f32 v63, v63, v48
    v_cvt_pk_bf16_f32 v48, v48, v48
    v_add_f32 v63, v63, v49
    v_cvt_pk_bf16_f32 v49, v49, v49
    v_add_f32 v63, v63, v50
    v_cvt_pk_bf16_f32 v50, v50, v50
    v_add_f32 v63, v63, v51
    v_cvt_pk_bf16_f32 v51, v51, v51
    v_add_f32 v63, v63, v52
    v_cvt_pk_bf16_f32 v52, v52, v52
    v_add_f32 v63, v63, v53
    v_cvt_pk_bf16_f32 v53, v53, v53
    v_add_f32 v63, v63, v54
    v_cvt_pk_bf16_f32 v54, v54, v54
    v_add_f32 v63, v63, v55
    v_cvt_pk_bf16_f32 v55, v55, v55
    v_add_f32 v63, v63, v56
    v_cvt_pk_bf16_f32 v56, v56, v56
    v_add_f32 v63, v63, v57
    v_cvt_pk_bf16_f32 v57, v57, v57
    v_add_f32 v63, v63, v58
    v_cvt_pk_bf16_f32 v58, v58, v58
    v_add_f32 v63, v63, v59
    v_cvt_pk_bf16_f32 v59, v59, v59
    v_add_f32 v63, v63, v60
    v_cvt_pk_bf16_f32 v60, v60, v60
    v_add_f32 v63, v63, v61
    v_cvt_pk_bf16_f32 v61, v61, v61
    s_nop 1
    v_add_f32_dpp v63, v63, v63 row_ror:4 row_mask:0xf bank_mask:0xf
    s_nop 1
    v_add_f32_dpp v63, v63, v63 row_ror:8 row_mask:0xf bank_mask:0xf
    s_nop 1
    v_add_f32_dpp v63, v63, v63 row_bcast:15 row_mask:0xa bank_mask:0xf
    s_nop 1
    v_add_f32_dpp v63, v63, v63 row_bcast:31 row_mask:0xc bank_mask:0xf
    s_nop 1
    v_readlane_b32 s82, v63, 63
    v_and_b32 v88, 8, v0
    v_cmp_ne_u32 s[66:67], 0, v88
    v_mov_b32 v63, s82
    v_lshlrev_b32 v89, 4, v88
    v_lshrrev_b32 v90, 4, v0
    v_lshl_add_u32 v89, v90, 5, v89
    v_and_b32 v90, 7, v0
    v_add_u32 v89, v89, v90
    s_lshl_b32 s5, s3, 8
    v_add_u32 v89, s5, v89
    v_lshlrev_b32 v114, 2, v89
    s_lshl_b32 s5, s3, 3
    v_mov_b32 v115, s5
    v_mov_b32 v119, 0
    s_lshl_b32 s5, s3, 6
    v_add_u32 v88, s5, v0
    v_lshlrev_b32 v120, 2, v88
    v_lshlrev_b32 v121, 4, v88
    s_lshl_b32 s86, s2, 12
    s_add_u32 s86, s86, 131072
    v_mov_b32 v109, s44
    v_mov_b32 v111, s44
    s_waitcnt vmcnt(24)
    v_and_b32_dpp v80, v40, v3 row_newbcast:0 row_mask:0xf bank_mask:0xf
    v_and_b32_dpp v81, v40, v4 row_newbcast:0 row_mask:0xf bank_mask:0xf
    v_and_b32_dpp v82, v40, v5 row_newbcast:0 row_mask:0xf bank_mask:0xf
    v_and_b32_dpp v83, v40, v6 row_newbcast:0 row_mask:0xf bank_mask:0xf
    v_and_b32_dpp v84, v40, v3 row_newbcast:4 row_mask:0xf bank_mask:0xf
    v_and_b32_dpp v85, v40, v4 row_newbcast:4 row_mask:0xf bank_mask:0xf
    v_and_b32_dpp v86, v40, v5 row_newbcast:4 row_mask:0xf bank_mask:0xf
    v_and_b32_dpp v87, v40, v6 row_newbcast:4 row_mask:0xf bank_mask:0xf
    v_mfma_f32_16x16x32_bf16 v[72:75], v[192:195], v[80:83], 0
    v_mfma_f32_16x16x32_bf16 v[76:79], v[196:199], v[80:83], 0
    v_and_b32_dpp v80, v40, v3 row_newbcast:8 row_mask:0xf bank_mask:0xf
    v_and_b32_dpp v81, v40, v4 row_newbcast:8 row_mask:0xf bank_mask:0xf
    v_and_b32_dpp v82, v40, v5 row_newbcast:8 row_mask:0xf bank_mask:0xf
    v_and_b32_dpp v83, v40, v6 row_newbcast:8 row_mask:0xf bank_mask:0xf
    v_mfma_f32_16x16x32_bf16 v[72:75], v[200:203], v[84:87], v[72:75]
    v_mfma_f32_16x16x32_bf16 v[76:79], v[204:207], v[84:87], v[76:79]
    v_and_b32_dpp v84, v40, v3 row_newbcast:12 row_mask:0xf bank_mask:0xf
    v_and_b32_dpp v85, v40, v4 row_newbcast:12 row_mask:0xf bank_mask:0xf
    v_and_b32_dpp v86, v40, v5 row_newbcast:12 row_mask:0xf bank_mask:0xf
    v_and_b32_dpp v87, v40, v6 row_newbcast:12 row_mask:0xf bank_mask:0xf
    v_mfma_f32_16x16x32_bf16 v[72:75], v[208:211], v[80:83], v[72:75]
    v_mfma_f32_16x16x32_bf16 v[76:79], v[212:215], v[80:83], v[76:79]
    s_nop 1
    v_mfma_f32_16x16x32_bf16 v[72:75], v[216:219], v[84:87], v[72:75]
    v_mfma_f32_16x16x32_bf16 v[76:79], v[220:223], v[84:87], v[76:79]
    s_mov_b32 s56, 131072
    s_mov_b32 s57, 135168
    buffer_load_dwordx4 a[64:67], v2, s[12:15], s56 offen offset:0 nt
    buffer_load_dwordx4 a[68:71], v2, s[12:15], s56 offen offset:256 nt
    buffer_load_dwordx4 a[72:75], v2, s[12:15], s56 offen offset:2048 nt
    buffer_load_dwordx4 a[76:79], v2, s[12:15], s56 offen offset:2304 nt
    buffer_load_dwordx4 a[80:83], v2, s[12:15], s57 offen offset:0 nt
    buffer_load_dwordx4 a[84:87], v2, s[12:15], s57 offen offset:256 nt
    buffer_load_dwordx4 a[88:91], v2, s[12:15], s57 offen offset:2048 nt
    buffer_load_dwordx4 a[92:95], v2, s[12:15], s57 offen offset:2304 nt
    s_waitcnt vmcnt(24)
    v_and_b32_dpp v80, v41, v3 row_newbcast:0 row_mask:0xf bank_mask:0xf
    v_and_b32_dpp v81, v41, v4 row_newbcast:0 row_mask:0xf bank_mask:0xf
    v_and_b32_dpp v82, v41, v5 row_newbcast:0 row_mask:0xf bank_mask:0xf
    v_and_b32_dpp v83, v41, v6 row_newbcast:0 row_mask:0xf bank_mask:0xf
    v_and_b32_dpp v84, v41, v3 row_newbcast:4 row_mask:0xf bank_mask:0xf
    v_and_b32_dpp v85, v41, v4 row_newbcast:4 row_mask:0xf bank_mask:0xf
    v_and_b32_dpp v86, v41, v5 row_newbcast:4 row_mask:0xf bank_mask:0xf
    v_and_b32_dpp v87, v41, v6 row_newbcast:4 row_mask:0xf bank_mask:0xf
    v_mfma_f32_16x16x32_bf16 v[72:75], v[224:227], v[80:83], v[72:75]
    v_mfma_f32_16x16x32_bf16 v[76:79], v[228:231], v[80:83], v[76:79]
    v_and_b32_dpp v80, v41, v3 row_newbcast:8 row_mask:0xf bank_mask:0xf
    v_and_b32_dpp v81, v41, v4 row_newbcast:8 row_mask:0xf bank_mask:0xf
    v_and_b32_dpp v82, v41, v5 row_newbcast:8 row_mask:0xf bank_mask:0xf
    v_and_b32_dpp v83, v41, v6 row_newbcast:8 row_mask:0xf bank_mask:0xf
    v_mfma_f32_16x16x32_bf16 v[72:75], v[232:235], v[84:87], v[72:75]
    v_mfma_f32_16x16x32_bf16 v[76:79], v[236:239], v[84:87], v[76:79]
    v_and_b32_dpp v84, v41, v3 row_newbcast:12 row_mask:0xf bank_mask:0xf
    v_and_b32_dpp v85, v41, v4 row_newbcast:12 row_mask:0xf bank_mask:0xf
    v_and_b32_dpp v86, v41, v5 row_newbcast:12 row_mask:0xf bank_mask:0xf
    v_and_b32_dpp v87, v41, v6 row_newbcast:12 row_mask:0xf bank_mask:0xf
    v_mfma_f32_16x16x32_bf16 v[72:75], v[240:243], v[80:83], v[72:75]
    v_mfma_f32_16x16x32_bf16 v[76:79], v[244:247], v[80:83], v[76:79]
    s_nop 1
    v_mfma_f32_16x16x32_bf16 v[72:75], v[248:251], v[84:87], v[72:75]
    v_mfma_f32_16x16x32_bf16 v[76:79], v[252:255], v[84:87], v[76:79]
    s_mov_b32 s56, 163840
    s_mov_b32 s57, 167936
    buffer_load_dwordx4 a[96:99], v2, s[12:15], s56 offen offset:0 nt
    buffer_load_dwordx4 a[100:103], v2, s[12:15], s56 offen offset:256 nt
    buffer_load_dwordx4 a[104:107], v2, s[12:15], s56 offen offset:2048 nt
    buffer_load_dwordx4 a[108:111], v2, s[12:15], s56 offen offset:2304 nt
    buffer_load_dwordx4 a[112:115], v2, s[12:15], s57 offen offset:0 nt
    buffer_load_dwordx4 a[116:119], v2, s[12:15], s57 offen offset:256 nt
    buffer_load_dwordx4 a[120:123], v2, s[12:15], s57 offen offset:2048 nt
    buffer_load_dwordx4 a[124:127], v2, s[12:15], s57 offen offset:2304 nt
    s_waitcnt vmcnt(24)
    v_and_b32_dpp v80, v42, v3 row_newbcast:0 row_mask:0xf bank_mask:0xf
    v_and_b32_dpp v81, v42, v4 row_newbcast:0 row_mask:0xf bank_mask:0xf
    v_and_b32_dpp v82, v42, v5 row_newbcast:0 row_mask:0xf bank_mask:0xf
    v_and_b32_dpp v83, v42, v6 row_newbcast:0 row_mask:0xf bank_mask:0xf
    v_and_b32_dpp v84, v42, v3 row_newbcast:4 row_mask:0xf bank_mask:0xf
    v_and_b32_dpp v85, v42, v4 row_newbcast:4 row_mask:0xf bank_mask:0xf
    v_and_b32_dpp v86, v42, v5 row_newbcast:4 row_mask:0xf bank_mask:0xf
    v_and_b32_dpp v87, v42, v6 row_newbcast:4 row_mask:0xf bank_mask:0xf
    v_mfma_f32_16x16x32_bf16 v[72:75], a[0:3], v[80:83], v[72:75]
    v_mfma_f32_16x16x32_bf16 v[76:79], a[4:7], v[80:83], v[76:79]
    v_and_b32_dpp v80, v42, v3 row_newbcast:8 row_mask:0xf bank_mask:0xf
    v_and_b32_dpp v81, v42, v4 row_newbcast:8 row_mask:0xf bank_mask:0xf
    v_and_b32_dpp v82, v42, v5 row_newbcast:8 row_mask:0xf bank_mask:0xf
    v_and_b32_dpp v83, v42, v6 row_newbcast:8 row_mask:0xf bank_mask:0xf
    v_mfma_f32_16x16x32_bf16 v[72:75], a[8:11], v[84:87], v[72:75]
    v_mfma_f32_16x16x32_bf16 v[76:79], a[12:15], v[84:87], v[76:79]
    v_and_b32_dpp v84, v42, v3 row_newbcast:12 row_mask:0xf bank_mask:0xf
    v_and_b32_dpp v85, v42, v4 row_newbcast:12 row_mask:0xf bank_mask:0xf
    v_and_b32_dpp v86, v42, v5 row_newbcast:12 row_mask:0xf bank_mask:0xf
    v_and_b32_dpp v87, v42, v6 row_newbcast:12 row_mask:0xf bank_mask:0xf
    v_mfma_f32_16x16x32_bf16 v[72:75], a[16:19], v[80:83], v[72:75]
    v_mfma_f32_16x16x32_bf16 v[76:79], a[20:23], v[80:83], v[76:79]
    s_nop 1
    v_mfma_f32_16x16x32_bf16 v[72:75], a[24:27], v[84:87], v[72:75]
    v_mfma_f32_16x16x32_bf16 v[76:79], a[28:31], v[84:87], v[76:79]
    s_mov_b32 s56, 196608
    s_mov_b32 s57, 200704
    buffer_load_dwordx4 a[128:131], v2, s[12:15], s56 offen offset:0 nt
    buffer_load_dwordx4 a[132:135], v2, s[12:15], s56 offen offset:256 nt
    buffer_load_dwordx4 a[136:139], v2, s[12:15], s56 offen offset:2048 nt
    buffer_load_dwordx4 a[140:143], v2, s[12:15], s56 offen offset:2304 nt
    buffer_load_dwordx4 a[144:147], v2, s[12:15], s57 offen offset:0 nt
    buffer_load_dwordx4 a[148:151], v2, s[12:15], s57 offen offset:256 nt
    buffer_load_dwordx4 a[152:155], v2, s[12:15], s57 offen offset:2048 nt
    buffer_load_dwordx4 a[156:159], v2, s[12:15], s57 offen offset:2304 nt
    s_waitcnt vmcnt(24)
    v_and_b32_dpp v80, v43, v3 row_newbcast:0 row_mask:0xf bank_mask:0xf
    v_and_b32_dpp v81, v43, v4 row_newbcast:0 row_mask:0xf bank_mask:0xf
    v_and_b32_dpp v82, v43, v5 row_newbcast:0 row_mask:0xf bank_mask:0xf
    v_and_b32_dpp v83, v43, v6 row_newbcast:0 row_mask:0xf bank_mask:0xf
    v_and_b32_dpp v84, v43, v3 row_newbcast:4 row_mask:0xf bank_mask:0xf
    v_and_b32_dpp v85, v43, v4 row_newbcast:4 row_mask:0xf bank_mask:0xf
    v_and_b32_dpp v86, v43, v5 row_newbcast:4 row_mask:0xf bank_mask:0xf
    v_and_b32_dpp v87, v43, v6 row_newbcast:4 row_mask:0xf bank_mask:0xf
    v_mfma_f32_16x16x32_bf16 v[72:75], a[32:35], v[80:83], v[72:75]
    v_mfma_f32_16x16x32_bf16 v[76:79], a[36:39], v[80:83], v[76:79]
    v_and_b32_dpp v80, v43, v3 row_newbcast:8 row_mask:0xf bank_mask:0xf
    v_and_b32_dpp v81, v43, v4 row_newbcast:8 row_mask:0xf bank_mask:0xf
    v_and_b32_dpp v82, v43, v5 row_newbcast:8 row_mask:0xf bank_mask:0xf
    v_and_b32_dpp v83, v43, v6 row_newbcast:8 row_mask:0xf bank_mask:0xf
    v_mfma_f32_16x16x32_bf16 v[72:75], a[40:43], v[84:87], v[72:75]
    v_mfma_f32_16x16x32_bf16 v[76:79], a[44:47], v[84:87], v[76:79]
    v_and_b32_dpp v84, v43, v3 row_newbcast:12 row_mask:0xf bank_mask:0xf
    v_and_b32_dpp v85, v43, v4 row_newbcast:12 row_mask:0xf bank_mask:0xf
    v_and_b32_dpp v86, v43, v5 row_newbcast:12 row_mask:0xf bank_mask:0xf
    v_and_b32_dpp v87, v43, v6 row_newbcast:12 row_mask:0xf bank_mask:0xf
    v_mfma_f32_16x16x32_bf16 v[72:75], a[48:51], v[80:83], v[72:75]
    v_mfma_f32_16x16x32_bf16 v[76:79], a[52:55], v[80:83], v[76:79]
    s_nop 1
    v_mfma_f32_16x16x32_bf16 v[72:75], a[56:59], v[84:87], v[72:75]
    v_mfma_f32_16x16x32_bf16 v[76:79], a[60:63], v[84:87], v[76:79]
    s_mov_b32 s56, 229376
    s_mov_b32 s57, 233472
    buffer_load_dwordx4 a[160:163], v2, s[12:15], s56 offen offset:0 nt
    buffer_load_dwordx4 a[164:167], v2, s[12:15], s56 offen offset:256 nt
    buffer_load_dwordx4 a[168:171], v2, s[12:15], s56 offen offset:2048 nt
    buffer_load_dwordx4 a[172:175], v2, s[12:15], s56 offen offset:2304 nt
    buffer_load_dwordx4 a[176:179], v2, s[12:15], s57 offen offset:0 nt
    buffer_load_dwordx4 a[180:183], v2, s[12:15], s57 offen offset:256 nt
    buffer_load_dwordx4 a[184:187], v2, s[12:15], s57 offen offset:2048 nt
    buffer_load_dwordx4 a[188:191], v2, s[12:15], s57 offen offset:2304 nt
    s_waitcnt vmcnt(24)
    v_and_b32_dpp v80, v44, v3 row_newbcast:0 row_mask:0xf bank_mask:0xf
    v_and_b32_dpp v81, v44, v4 row_newbcast:0 row_mask:0xf bank_mask:0xf
    v_and_b32_dpp v82, v44, v5 row_newbcast:0 row_mask:0xf bank_mask:0xf
    v_and_b32_dpp v83, v44, v6 row_newbcast:0 row_mask:0xf bank_mask:0xf
    v_and_b32_dpp v84, v44, v3 row_newbcast:4 row_mask:0xf bank_mask:0xf
    v_and_b32_dpp v85, v44, v4 row_newbcast:4 row_mask:0xf bank_mask:0xf
    v_and_b32_dpp v86, v44, v5 row_newbcast:4 row_mask:0xf bank_mask:0xf
    v_and_b32_dpp v87, v44, v6 row_newbcast:4 row_mask:0xf bank_mask:0xf
    v_mfma_f32_16x16x32_bf16 v[72:75], a[64:67], v[80:83], v[72:75]
    v_mfma_f32_16x16x32_bf16 v[76:79], a[68:71], v[80:83], v[76:79]
    v_and_b32_dpp v80, v44, v3 row_newbcast:8 row_mask:0xf bank_mask:0xf
    v_and_b32_dpp v81, v44, v4 row_newbcast:8 row_mask:0xf bank_mask:0xf
    v_and_b32_dpp v82, v44, v5 row_newbcast:8 row_mask:0xf bank_mask:0xf
    v_and_b32_dpp v83, v44, v6 row_newbcast:8 row_mask:0xf bank_mask:0xf
    v_mfma_f32_16x16x32_bf16 v[72:75], a[72:75], v[84:87], v[72:75]
    v_mfma_f32_16x16x32_bf16 v[76:79], a[76:79], v[84:87], v[76:79]
    v_and_b32_dpp v84, v44, v3 row_newbcast:12 row_mask:0xf bank_mask:0xf
    v_and_b32_dpp v85, v44, v4 row_newbcast:12 row_mask:0xf bank_mask:0xf
    v_and_b32_dpp v86, v44, v5 row_newbcast:12 row_mask:0xf bank_mask:0xf
    v_and_b32_dpp v87, v44, v6 row_newbcast:12 row_mask:0xf bank_mask:0xf
    v_mfma_f32_16x16x32_bf16 v[72:75], a[80:83], v[80:83], v[72:75]
    v_mfma_f32_16x16x32_bf16 v[76:79], a[84:87], v[80:83], v[76:79]
    s_nop 1
    v_mfma_f32_16x16x32_bf16 v[72:75], a[88:91], v[84:87], v[72:75]
    v_mfma_f32_16x16x32_bf16 v[76:79], a[92:95], v[84:87], v[76:79]
    s_mov_b32 s56, 262144
    s_mov_b32 s57, 266240
    buffer_load_dwordx4 a[192:195], v2, s[12:15], s56 offen offset:0 nt
    buffer_load_dwordx4 a[196:199], v2, s[12:15], s56 offen offset:256 nt
    buffer_load_dwordx4 a[200:203], v2, s[12:15], s56 offen offset:2048 nt
    buffer_load_dwordx4 a[204:207], v2, s[12:15], s56 offen offset:2304 nt
    buffer_load_dwordx4 a[208:211], v2, s[12:15], s57 offen offset:0 nt
    buffer_load_dwordx4 a[212:215], v2, s[12:15], s57 offen offset:256 nt
    buffer_load_dwordx4 a[216:219], v2, s[12:15], s57 offen offset:2048 nt
    buffer_load_dwordx4 a[220:223], v2, s[12:15], s57 offen offset:2304 nt
    s_waitcnt vmcnt(24)
    v_and_b32_dpp v80, v45, v3 row_newbcast:0 row_mask:0xf bank_mask:0xf
    v_and_b32_dpp v81, v45, v4 row_newbcast:0 row_mask:0xf bank_mask:0xf
    v_and_b32_dpp v82, v45, v5 row_newbcast:0 row_mask:0xf bank_mask:0xf
    v_and_b32_dpp v83, v45, v6 row_newbcast:0 row_mask:0xf bank_mask:0xf
    v_and_b32_dpp v84, v45, v3 row_newbcast:4 row_mask:0xf bank_mask:0xf
    v_and_b32_dpp v85, v45, v4 row_newbcast:4 row_mask:0xf bank_mask:0xf
    v_and_b32_dpp v86, v45, v5 row_newbcast:4 row_mask:0xf bank_mask:0xf
    v_and_b32_dpp v87, v45, v6 row_newbcast:4 row_mask:0xf bank_mask:0xf
    v_mfma_f32_16x16x32_bf16 v[72:75], a[96:99], v[80:83], v[72:75]
    v_mfma_f32_16x16x32_bf16 v[76:79], a[100:103], v[80:83], v[76:79]
    v_and_b32_dpp v80, v45, v3 row_newbcast:8 row_mask:0xf bank_mask:0xf
    v_and_b32_dpp v81, v45, v4 row_newbcast:8 row_mask:0xf bank_mask:0xf
    v_and_b32_dpp v82, v45, v5 row_newbcast:8 row_mask:0xf bank_mask:0xf
    v_and_b32_dpp v83, v45, v6 row_newbcast:8 row_mask:0xf bank_mask:0xf
    v_mfma_f32_16x16x32_bf16 v[72:75], a[104:107], v[84:87], v[72:75]
    v_mfma_f32_16x16x32_bf16 v[76:79], a[108:111], v[84:87], v[76:79]
    v_and_b32_dpp v84, v45, v3 row_newbcast:12 row_mask:0xf bank_mask:0xf
    v_and_b32_dpp v85, v45, v4 row_newbcast:12 row_mask:0xf bank_mask:0xf
    v_and_b32_dpp v86, v45, v5 row_newbcast:12 row_mask:0xf bank_mask:0xf
    v_and_b32_dpp v87, v45, v6 row_newbcast:12 row_mask:0xf bank_mask:0xf
    v_mfma_f32_16x16x32_bf16 v[72:75], a[112:115], v[80:83], v[72:75]
    v_mfma_f32_16x16x32_bf16 v[76:79], a[116:119], v[80:83], v[76:79]
    s_nop 1
    v_mfma_f32_16x16x32_bf16 v[72:75], a[120:123], v[84:87], v[72:75]
    v_mfma_f32_16x16x32_bf16 v[76:79], a[124:127], v[84:87], v[76:79]
    s_mov_b32 s56, 294912
    s_mov_b32 s57, 299008
    buffer_load_dwordx4 a[224:227], v2, s[12:15], s56 offen offset:0 nt
    buffer_load_dwordx4 a[228:231], v2, s[12:15], s56 offen offset:256 nt
    buffer_load_dwordx4 a[232:235], v2, s[12:15], s56 offen offset:2048 nt
    buffer_load_dwordx4 a[236:239], v2, s[12:15], s56 offen offset:2304 nt
    buffer_load_dwordx4 a[240:243], v2, s[12:15], s57 offen offset:0 nt
    buffer_load_dwordx4 a[244:247], v2, s[12:15], s57 offen offset:256 nt
    buffer_load_dwordx4 a[248:251], v2, s[12:15], s57 offen offset:2048 nt
    buffer_load_dwordx4 a[252:255], v2, s[12:15], s57 offen offset:2304 nt
    s_waitcnt vmcnt(24)
    v_and_b32_dpp v80, v46, v3 row_newbcast:0 row_mask:0xf bank_mask:0xf
    v_and_b32_dpp v81, v46, v4 row_newbcast:0 row_mask:0xf bank_mask:0xf
    v_and_b32_dpp v82, v46, v5 row_newbcast:0 row_mask:0xf bank_mask:0xf
    v_and_b32_dpp v83, v46, v6 row_newbcast:0 row_mask:0xf bank_mask:0xf
    v_and_b32_dpp v84, v46, v3 row_newbcast:4 row_mask:0xf bank_mask:0xf
    v_and_b32_dpp v85, v46, v4 row_newbcast:4 row_mask:0xf bank_mask:0xf
    v_and_b32_dpp v86, v46, v5 row_newbcast:4 row_mask:0xf bank_mask:0xf
    v_and_b32_dpp v87, v46, v6 row_newbcast:4 row_mask:0xf bank_mask:0xf
    v_mfma_f32_16x16x32_bf16 v[72:75], a[128:131], v[80:83], v[72:75]
    v_mfma_f32_16x16x32_bf16 v[76:79], a[132:135], v[80:83], v[76:79]
    v_and_b32_dpp v80, v46, v3 row_newbcast:8 row_mask:0xf bank_mask:0xf
    v_and_b32_dpp v81, v46, v4 row_newbcast:8 row_mask:0xf bank_mask:0xf
    v_and_b32_dpp v82, v46, v5 row_newbcast:8 row_mask:0xf bank_mask:0xf
    v_and_b32_dpp v83, v46, v6 row_newbcast:8 row_mask:0xf bank_mask:0xf
    v_mfma_f32_16x16x32_bf16 v[72:75], a[136:139], v[84:87], v[72:75]
    v_mfma_f32_16x16x32_bf16 v[76:79], a[140:143], v[84:87], v[76:79]
    v_and_b32_dpp v84, v46, v3 row_newbcast:12 row_mask:0xf bank_mask:0xf
    v_and_b32_dpp v85, v46, v4 row_newbcast:12 row_mask:0xf bank_mask:0xf
    v_and_b32_dpp v86, v46, v5 row_newbcast:12 row_mask:0xf bank_mask:0xf
    v_and_b32_dpp v87, v46, v6 row_newbcast:12 row_mask:0xf bank_mask:0xf
    v_mfma_f32_16x16x32_bf16 v[72:75], a[144:147], v[80:83], v[72:75]
    v_mfma_f32_16x16x32_bf16 v[76:79], a[148:151], v[80:83], v[76:79]
    s_nop 1
    v_mfma_f32_16x16x32_bf16 v[72:75], a[152:155], v[84:87], v[72:75]
    v_mfma_f32_16x16x32_bf16 v[76:79], a[156:159], v[84:87], v[76:79]
    s_mov_b32 s56, 327680
    s_mov_b32 s57, 331776
    buffer_load_dwordx4 v[128:131], v2, s[12:15], s56 offen offset:0 nt
    buffer_load_dwordx4 v[132:135], v2, s[12:15], s56 offen offset:256 nt
    buffer_load_dwordx4 v[136:139], v2, s[12:15], s56 offen offset:2048 nt
    buffer_load_dwordx4 v[140:143], v2, s[12:15], s56 offen offset:2304 nt
    buffer_load_dwordx4 v[144:147], v2, s[12:15], s57 offen offset:0 nt
    buffer_load_dwordx4 v[148:151], v2, s[12:15], s57 offen offset:256 nt
    buffer_load_dwordx4 v[152:155], v2, s[12:15], s57 offen offset:2048 nt
    buffer_load_dwordx4 v[156:159], v2, s[12:15], s57 offen offset:2304 nt
    s_waitcnt vmcnt(24)
    v_and_b32_dpp v80, v47, v3 row_newbcast:0 row_mask:0xf bank_mask:0xf
    v_and_b32_dpp v81, v47, v4 row_newbcast:0 row_mask:0xf bank_mask:0xf
    v_and_b32_dpp v82, v47, v5 row_newbcast:0 row_mask:0xf bank_mask:0xf
    v_and_b32_dpp v83, v47, v6 row_newbcast:0 row_mask:0xf bank_mask:0xf
    v_and_b32_dpp v84, v47, v3 row_newbcast:4 row_mask:0xf bank_mask:0xf
    v_and_b32_dpp v85, v47, v4 row_newbcast:4 row_mask:0xf bank_mask:0xf
    v_and_b32_dpp v86, v47, v5 row_newbcast:4 row_mask:0xf bank_mask:0xf
    v_and_b32_dpp v87, v47, v6 row_newbcast:4 row_mask:0xf bank_mask:0xf
    v_mfma_f32_16x16x32_bf16 v[72:75], a[160:163], v[80:83], v[72:75]
    v_mfma_f32_16x16x32_bf16 v[76:79], a[164:167], v[80:83], v[76:79]
    v_and_b32_dpp v80, v47, v3 row_newbcast:8 row_mask:0xf bank_mask:0xf
    v_and_b32_dpp v81, v47, v4 row_newbcast:8 row_mask:0xf bank_mask:0xf
    v_and_b32_dpp v82, v47, v5 row_newbcast:8 row_mask:0xf bank_mask:0xf
    v_and_b32_dpp v83, v47, v6 row_newbcast:8 row_mask:0xf bank_mask:0xf
    v_mfma_f32_16x16x32_bf16 v[72:75], a[168:171], v[84:87], v[72:75]
    v_mfma_f32_16x16x32_bf16 v[76:79], a[172:175], v[84:87], v[76:79]
    v_and_b32_dpp v84, v47, v3 row_newbcast:12 row_mask:0xf bank_mask:0xf
    v_and_b32_dpp v85, v47, v4 row_newbcast:12 row_mask:0xf bank_mask:0xf
    v_and_b32_dpp v86, v47, v5 row_newbcast:12 row_mask:0xf bank_mask:0xf
    v_and_b32_dpp v87, v47, v6 row_newbcast:12 row_mask:0xf bank_mask:0xf
    v_mfma_f32_16x16x32_bf16 v[72:75], a[176:179], v[80:83], v[72:75]
    v_mfma_f32_16x16x32_bf16 v[76:79], a[180:183], v[80:83], v[76:79]
    s_nop 1
    v_mfma_f32_16x16x32_bf16 v[72:75], a[184:187], v[84:87], v[72:75]
    v_mfma_f32_16x16x32_bf16 v[76:79], a[188:191], v[84:87], v[76:79]
    s_mov_b32 s56, 360448
    s_mov_b32 s57, 364544
    buffer_load_dwordx4 v[160:163], v2, s[12:15], s56 offen offset:0 nt
    buffer_load_dwordx4 v[164:167], v2, s[12:15], s56 offen offset:256 nt
    buffer_load_dwordx4 v[168:171], v2, s[12:15], s56 offen offset:2048 nt
    buffer_load_dwordx4 v[172:175], v2, s[12:15], s56 offen offset:2304 nt
    buffer_load_dwordx4 v[176:179], v2, s[12:15], s57 offen offset:0 nt
    buffer_load_dwordx4 v[180:183], v2, s[12:15], s57 offen offset:256 nt
    buffer_load_dwordx4 v[184:187], v2, s[12:15], s57 offen offset:2048 nt
    buffer_load_dwordx4 v[188:191], v2, s[12:15], s57 offen offset:2304 nt
    s_waitcnt vmcnt(24)
    v_and_b32_dpp v80, v48, v3 row_newbcast:0 row_mask:0xf bank_mask:0xf
    v_and_b32_dpp v81, v48, v4 row_newbcast:0 row_mask:0xf bank_mask:0xf
    v_and_b32_dpp v82, v48, v5 row_newbcast:0 row_mask:0xf bank_mask:0xf
    v_and_b32_dpp v83, v48, v6 row_newbcast:0 row_mask:0xf bank_mask:0xf
    v_and_b32_dpp v84, v48, v3 row_newbcast:4 row_mask:0xf bank_mask:0xf
    v_and_b32_dpp v85, v48, v4 row_newbcast:4 row_mask:0xf bank_mask:0xf
    v_and_b32_dpp v86, v48, v5 row_newbcast:4 row_mask:0xf bank_mask:0xf
    v_and_b32_dpp v87, v48, v6 row_newbcast:4 row_mask:0xf bank_mask:0xf
    v_mfma_f32_16x16x32_bf16 v[72:75], a[192:195], v[80:83], v[72:75]
    v_mfma_f32_16x16x32_bf16 v[76:79], a[196:199], v[80:83], v[76:79]
    v_and_b32_dpp v80, v48, v3 row_newbcast:8 row_mask:0xf bank_mask:0xf
    v_and_b32_dpp v81, v48, v4 row_newbcast:8 row_mask:0xf bank_mask:0xf
    v_and_b32_dpp v82, v48, v5 row_newbcast:8 row_mask:0xf bank_mask:0xf
    v_and_b32_dpp v83, v48, v6 row_newbcast:8 row_mask:0xf bank_mask:0xf
    v_mfma_f32_16x16x32_bf16 v[72:75], a[200:203], v[84:87], v[72:75]
    v_mfma_f32_16x16x32_bf16 v[76:79], a[204:207], v[84:87], v[76:79]
    v_and_b32_dpp v84, v48, v3 row_newbcast:12 row_mask:0xf bank_mask:0xf
    v_and_b32_dpp v85, v48, v4 row_newbcast:12 row_mask:0xf bank_mask:0xf
    v_and_b32_dpp v86, v48, v5 row_newbcast:12 row_mask:0xf bank_mask:0xf
    v_and_b32_dpp v87, v48, v6 row_newbcast:12 row_mask:0xf bank_mask:0xf
    v_mfma_f32_16x16x32_bf16 v[72:75], a[208:211], v[80:83], v[72:75]
    v_mfma_f32_16x16x32_bf16 v[76:79], a[212:215], v[80:83], v[76:79]
    s_nop 1
    v_mfma_f32_16x16x32_bf16 v[72:75], a[216:219], v[84:87], v[72:75]
    v_mfma_f32_16x16x32_bf16 v[76:79], a[220:223], v[84:87], v[76:79]
    s_mov_b32 s56, 393216
    s_mov_b32 s57, 397312
    buffer_load_dwordx4 v[192:195], v2, s[12:15], s56 offen offset:0 nt
    buffer_load_dwordx4 v[196:199], v2, s[12:15], s56 offen offset:256 nt
    buffer_load_dwordx4 v[200:203], v2, s[12:15], s56 offen offset:2048 nt
    buffer_load_dwordx4 v[204:207], v2, s[12:15], s56 offen offset:2304 nt
    buffer_load_dwordx4 v[208:211], v2, s[12:15], s57 offen offset:0 nt
    buffer_load_dwordx4 v[212:215], v2, s[12:15], s57 offen offset:256 nt
    buffer_load_dwordx4 v[216:219], v2, s[12:15], s57 offen offset:2048 nt
    buffer_load_dwordx4 v[220:223], v2, s[12:15], s57 offen offset:2304 nt
    s_waitcnt vmcnt(24)
    v_and_b32_dpp v80, v49, v3 row_newbcast:0 row_mask:0xf bank_mask:0xf
    v_and_b32_dpp v81, v49, v4 row_newbcast:0 row_mask:0xf bank_mask:0xf
    v_and_b32_dpp v82, v49, v5 row_newbcast:0 row_mask:0xf bank_mask:0xf
    v_and_b32_dpp v83, v49, v6 row_newbcast:0 row_mask:0xf bank_mask:0xf
    v_and_b32_dpp v84, v49, v3 row_newbcast:4 row_mask:0xf bank_mask:0xf
    v_and_b32_dpp v85, v49, v4 row_newbcast:4 row_mask:0xf bank_mask:0xf
    v_and_b32_dpp v86, v49, v5 row_newbcast:4 row_mask:0xf bank_mask:0xf
    v_and_b32_dpp v87, v49, v6 row_newbcast:4 row_mask:0xf bank_mask:0xf
    v_mfma_f32_16x16x32_bf16 v[72:75], a[224:227], v[80:83], v[72:75]
    v_mfma_f32_16x16x32_bf16 v[76:79], a[228:231], v[80:83], v[76:79]
    v_and_b32_dpp v80, v49, v3 row_newbcast:8 row_mask:0xf bank_mask:0xf
    v_and_b32_dpp v81, v49, v4 row_newbcast:8 row_mask:0xf bank_mask:0xf
    v_and_b32_dpp v82, v49, v5 row_newbcast:8 row_mask:0xf bank_mask:0xf
    v_and_b32_dpp v83, v49, v6 row_newbcast:8 row_mask:0xf bank_mask:0xf
    v_mfma_f32_16x16x32_bf16 v[72:75], a[232:235], v[84:87], v[72:75]
    v_mfma_f32_16x16x32_bf16 v[76:79], a[236:239], v[84:87], v[76:79]
    v_and_b32_dpp v84, v49, v3 row_newbcast:12 row_mask:0xf bank_mask:0xf
    v_and_b32_dpp v85, v49, v4 row_newbcast:12 row_mask:0xf bank_mask:0xf
    v_and_b32_dpp v86, v49, v5 row_newbcast:12 row_mask:0xf bank_mask:0xf
    v_and_b32_dpp v87, v49, v6 row_newbcast:12 row_mask:0xf bank_mask:0xf
    v_mfma_f32_16x16x32_bf16 v[72:75], a[240:243], v[80:83], v[72:75]
    v_mfma_f32_16x16x32_bf16 v[76:79], a[244:247], v[80:83], v[76:79]
    s_nop 1
    v_mfma_f32_16x16x32_bf16 v[72:75], a[248:251], v[84:87], v[72:75]
    v_mfma_f32_16x16x32_bf16 v[76:79], a[252:255], v[84:87], v[76:79]
    s_mov_b32 s56, 425984
    s_mov_b32 s57, 430080
    buffer_load_dwordx4 v[224:227], v2, s[12:15], s56 offen offset:0 nt
    buffer_load_dwordx4 v[228:231], v2, s[12:15], s56 offen offset:256 nt
    buffer_load_dwordx4 v[232:235], v2, s[12:15], s56 offen offset:2048 nt
    buffer_load_dwordx4 v[236:239], v2, s[12:15], s56 offen offset:2304 nt
    buffer_load_dwordx4 v[240:243], v2, s[12:15], s57 offen offset:0 nt
    buffer_load_dwordx4 v[244:247], v2, s[12:15], s57 offen offset:256 nt
    buffer_load_dwordx4 v[248:251], v2, s[12:15], s57 offen offset:2048 nt
    buffer_load_dwordx4 v[252:255], v2, s[12:15], s57 offen offset:2304 nt
    s_waitcnt vmcnt(24)
    v_and_b32_dpp v80, v50, v3 row_newbcast:0 row_mask:0xf bank_mask:0xf
    v_and_b32_dpp v81, v50, v4 row_newbcast:0 row_mask:0xf bank_mask:0xf
    v_and_b32_dpp v82, v50, v5 row_newbcast:0 row_mask:0xf bank_mask:0xf
    v_and_b32_dpp v83, v50, v6 row_newbcast:0 row_mask:0xf bank_mask:0xf
    v_and_b32_dpp v84, v50, v3 row_newbcast:4 row_mask:0xf bank_mask:0xf
    v_and_b32_dpp v85, v50, v4 row_newbcast:4 row_mask:0xf bank_mask:0xf
    v_and_b32_dpp v86, v50, v5 row_newbcast:4 row_mask:0xf bank_mask:0xf
    v_and_b32_dpp v87, v50, v6 row_newbcast:4 row_mask:0xf bank_mask:0xf
    v_mfma_f32_16x16x32_bf16 v[72:75], v[128:131], v[80:83], v[72:75]
    v_mfma_f32_16x16x32_bf16 v[76:79], v[132:135], v[80:83], v[76:79]
    v_and_b32_dpp v80, v50, v3 row_newbcast:8 row_mask:0xf bank_mask:0xf
    v_and_b32_dpp v81, v50, v4 row_newbcast:8 row_mask:0xf bank_mask:0xf
    v_and_b32_dpp v82, v50, v5 row_newbcast:8 row_mask:0xf bank_mask:0xf
    v_and_b32_dpp v83, v50, v6 row_newbcast:8 row_mask:0xf bank_mask:0xf
    v_mfma_f32_16x16x32_bf16 v[72:75], v[136:139], v[84:87], v[72:75]
    v_mfma_f32_16x16x32_bf16 v[76:79], v[140:143], v[84:87], v[76:79]
    v_and_b32_dpp v84, v50, v3 row_newbcast:12 row_mask:0xf bank_mask:0xf
    v_and_b32_dpp v85, v50, v4 row_newbcast:12 row_mask:0xf bank_mask:0xf
    v_and_b32_dpp v86, v50, v5 row_newbcast:12 row_mask:0xf bank_mask:0xf
    v_and_b32_dpp v87, v50, v6 row_newbcast:12 row_mask:0xf bank_mask:0xf
    v_mfma_f32_16x16x32_bf16 v[72:75], v[144:147], v[80:83], v[72:75]
    v_mfma_f32_16x16x32_bf16 v[76:79], v[148:151], v[80:83], v[76:79]
    s_nop 1
    v_mfma_f32_16x16x32_bf16 v[72:75], v[152:155], v[84:87], v[72:75]
    v_mfma_f32_16x16x32_bf16 v[76:79], v[156:159], v[84:87], v[76:79]
    s_mov_b32 s56, 458752
    s_mov_b32 s57, 462848
    buffer_load_dwordx4 a[0:3], v2, s[12:15], s56 offen offset:0 nt
    buffer_load_dwordx4 a[4:7], v2, s[12:15], s56 offen offset:256 nt
    buffer_load_dwordx4 a[8:11], v2, s[12:15], s56 offen offset:2048 nt
    buffer_load_dwordx4 a[12:15], v2, s[12:15], s56 offen offset:2304 nt
    buffer_load_dwordx4 a[16:19], v2, s[12:15], s57 offen offset:0 nt
    buffer_load_dwordx4 a[20:23], v2, s[12:15], s57 offen offset:256 nt
    buffer_load_dwordx4 a[24:27], v2, s[12:15], s57 offen offset:2048 nt
    buffer_load_dwordx4 a[28:31], v2, s[12:15], s57 offen offset:2304 nt
    s_waitcnt vmcnt(24)
    v_and_b32_dpp v80, v51, v3 row_newbcast:0 row_mask:0xf bank_mask:0xf
    v_and_b32_dpp v81, v51, v4 row_newbcast:0 row_mask:0xf bank_mask:0xf
    v_and_b32_dpp v82, v51, v5 row_newbcast:0 row_mask:0xf bank_mask:0xf
    v_and_b32_dpp v83, v51, v6 row_newbcast:0 row_mask:0xf bank_mask:0xf
    v_and_b32_dpp v84, v51, v3 row_newbcast:4 row_mask:0xf bank_mask:0xf
    v_and_b32_dpp v85, v51, v4 row_newbcast:4 row_mask:0xf bank_mask:0xf
    v_and_b32_dpp v86, v51, v5 row_newbcast:4 row_mask:0xf bank_mask:0xf
    v_and_b32_dpp v87, v51, v6 row_newbcast:4 row_mask:0xf bank_mask:0xf
    v_mfma_f32_16x16x32_bf16 v[72:75], v[160:163], v[80:83], v[72:75]
    v_mfma_f32_16x16x32_bf16 v[76:79], v[164:167], v[80:83], v[76:79]
    v_and_b32_dpp v80, v51, v3 row_newbcast:8 row_mask:0xf bank_mask:0xf
    v_and_b32_dpp v81, v51, v4 row_newbcast:8 row_mask:0xf bank_mask:0xf
    v_and_b32_dpp v82, v51, v5 row_newbcast:8 row_mask:0xf bank_mask:0xf
    v_and_b32_dpp v83, v51, v6 row_newbcast:8 row_mask:0xf bank_mask:0xf
    v_mfma_f32_16x16x32_bf16 v[72:75], v[168:171], v[84:87], v[72:75]
    v_mfma_f32_16x16x32_bf16 v[76:79], v[172:175], v[84:87], v[76:79]
    v_and_b32_dpp v84, v51, v3 row_newbcast:12 row_mask:0xf bank_mask:0xf
    v_and_b32_dpp v85, v51, v4 row_newbcast:12 row_mask:0xf bank_mask:0xf
    v_and_b32_dpp v86, v51, v5 row_newbcast:12 row_mask:0xf bank_mask:0xf
    v_and_b32_dpp v87, v51, v6 row_newbcast:12 row_mask:0xf bank_mask:0xf
    v_mfma_f32_16x16x32_bf16 v[72:75], v[176:179], v[80:83], v[72:75]
    v_mfma_f32_16x16x32_bf16 v[76:79], v[180:183], v[80:83], v[76:79]
    s_nop 1
    v_mfma_f32_16x16x32_bf16 v[72:75], v[184:187], v[84:87], v[72:75]
    v_mfma_f32_16x16x32_bf16 v[76:79], v[188:191], v[84:87], v[76:79]
    s_mov_b32 s56, 491520
    s_mov_b32 s57, 495616
    buffer_load_dwordx4 a[32:35], v2, s[12:15], s56 offen offset:0 nt
    buffer_load_dwordx4 a[36:39], v2, s[12:15], s56 offen offset:256 nt
    buffer_load_dwordx4 a[40:43], v2, s[12:15], s56 offen offset:2048 nt
    buffer_load_dwordx4 a[44:47], v2, s[12:15], s56 offen offset:2304 nt
    buffer_load_dwordx4 a[48:51], v2, s[12:15], s57 offen offset:0 nt
    buffer_load_dwordx4 a[52:55], v2, s[12:15], s57 offen offset:256 nt
    buffer_load_dwordx4 a[56:59], v2, s[12:15], s57 offen offset:2048 nt
    buffer_load_dwordx4 a[60:63], v2, s[12:15], s57 offen offset:2304 nt
    s_waitcnt vmcnt(24)
    v_and_b32_dpp v80, v52, v3 row_newbcast:0 row_mask:0xf bank_mask:0xf
    v_and_b32_dpp v81, v52, v4 row_newbcast:0 row_mask:0xf bank_mask:0xf
    v_and_b32_dpp v82, v52, v5 row_newbcast:0 row_mask:0xf bank_mask:0xf
    v_and_b32_dpp v83, v52, v6 row_newbcast:0 row_mask:0xf bank_mask:0xf
    v_and_b32_dpp v84, v52, v3 row_newbcast:4 row_mask:0xf bank_mask:0xf
    v_and_b32_dpp v85, v52, v4 row_newbcast:4 row_mask:0xf bank_mask:0xf
    v_and_b32_dpp v86, v52, v5 row_newbcast:4 row_mask:0xf bank_mask:0xf
    v_and_b32_dpp v87, v52, v6 row_newbcast:4 row_mask:0xf bank_mask:0xf
    v_mfma_f32_16x16x32_bf16 v[72:75], v[192:195], v[80:83], v[72:75]
    v_mfma_f32_16x16x32_bf16 v[76:79], v[196:199], v[80:83], v[76:79]
    v_and_b32_dpp v80, v52, v3 row_newbcast:8 row_mask:0xf bank_mask:0xf
    v_and_b32_dpp v81, v52, v4 row_newbcast:8 row_mask:0xf bank_mask:0xf
    v_and_b32_dpp v82, v52, v5 row_newbcast:8 row_mask:0xf bank_mask:0xf
    v_and_b32_dpp v83, v52, v6 row_newbcast:8 row_mask:0xf bank_mask:0xf
    v_mfma_f32_16x16x32_bf16 v[72:75], v[200:203], v[84:87], v[72:75]
    v_mfma_f32_16x16x32_bf16 v[76:79], v[204:207], v[84:87], v[76:79]
    v_and_b32_dpp v84, v52, v3 row_newbcast:12 row_mask:0xf bank_mask:0xf
    v_and_b32_dpp v85, v52, v4 row_newbcast:12 row_mask:0xf bank_mask:0xf
    v_and_b32_dpp v86, v52, v5 row_newbcast:12 row_mask:0xf bank_mask:0xf
    v_and_b32_dpp v87, v52, v6 row_newbcast:12 row_mask:0xf bank_mask:0xf
    v_mfma_f32_16x16x32_bf16 v[72:75], v[208:211], v[80:83], v[72:75]
    v_mfma_f32_16x16x32_bf16 v[76:79], v[212:215], v[80:83], v[76:79]
    s_nop 1
    v_mfma_f32_16x16x32_bf16 v[72:75], v[216:219], v[84:87], v[72:75]
    v_mfma_f32_16x16x32_bf16 v[76:79], v[220:223], v[84:87], v[76:79]
    s_mov_b32 s56, 524288
    s_mov_b32 s57, 528384
    buffer_load_dwordx4 a[64:67], v2, s[12:15], s56 offen offset:0 nt
    buffer_load_dwordx4 a[68:71], v2, s[12:15], s56 offen offset:256 nt
    buffer_load_dwordx4 a[72:75], v2, s[12:15], s56 offen offset:2048 nt
    buffer_load_dwordx4 a[76:79], v2, s[12:15], s56 offen offset:2304 nt
    buffer_load_dwordx4 a[80:83], v2, s[12:15], s57 offen offset:0 nt
    buffer_load_dwordx4 a[84:87], v2, s[12:15], s57 offen offset:256 nt
    buffer_load_dwordx4 a[88:91], v2, s[12:15], s57 offen offset:2048 nt
    buffer_load_dwordx4 a[92:95], v2, s[12:15], s57 offen offset:2304 nt
    s_waitcnt vmcnt(24)
    v_and_b32_dpp v80, v53, v3 row_newbcast:0 row_mask:0xf bank_mask:0xf
    v_and_b32_dpp v81, v53, v4 row_newbcast:0 row_mask:0xf bank_mask:0xf
    v_and_b32_dpp v82, v53, v5 row_newbcast:0 row_mask:0xf bank_mask:0xf
    v_and_b32_dpp v83, v53, v6 row_newbcast:0 row_mask:0xf bank_mask:0xf
    v_and_b32_dpp v84, v53, v3 row_newbcast:4 row_mask:0xf bank_mask:0xf
    v_and_b32_dpp v85, v53, v4 row_newbcast:4 row_mask:0xf bank_mask:0xf
    v_and_b32_dpp v86, v53, v5 row_newbcast:4 row_mask:0xf bank_mask:0xf
    v_and_b32_dpp v87, v53, v6 row_newbcast:4 row_mask:0xf bank_mask:0xf
    v_mfma_f32_16x16x32_bf16 v[72:75], v[224:227], v[80:83], v[72:75]
    v_mfma_f32_16x16x32_bf16 v[76:79], v[228:231], v[80:83], v[76:79]
    v_and_b32_dpp v80, v53, v3 row_newbcast:8 row_mask:0xf bank_mask:0xf
    v_and_b32_dpp v81, v53, v4 row_newbcast:8 row_mask:0xf bank_mask:0xf
    v_and_b32_dpp v82, v53, v5 row_newbcast:8 row_mask:0xf bank_mask:0xf
    v_and_b32_dpp v83, v53, v6 row_newbcast:8 row_mask:0xf bank_mask:0xf
    v_mfma_f32_16x16x32_bf16 v[72:75], v[232:235], v[84:87], v[72:75]
    v_mfma_f32_16x16x32_bf16 v[76:79], v[236:239], v[84:87], v[76:79]
    v_and_b32_dpp v84, v53, v3 row_newbcast:12 row_mask:0xf bank_mask:0xf
    v_and_b32_dpp v85, v53, v4 row_newbcast:12 row_mask:0xf bank_mask:0xf
    v_and_b32_dpp v86, v53, v5 row_newbcast:12 row_mask:0xf bank_mask:0xf
    v_and_b32_dpp v87, v53, v6 row_newbcast:12 row_mask:0xf bank_mask:0xf
    v_mfma_f32_16x16x32_bf16 v[72:75], v[240:243], v[80:83], v[72:75]
    v_mfma_f32_16x16x32_bf16 v[76:79], v[244:247], v[80:83], v[76:79]
    s_nop 1
    v_mfma_f32_16x16x32_bf16 v[72:75], v[248:251], v[84:87], v[72:75]
    v_mfma_f32_16x16x32_bf16 v[76:79], v[252:255], v[84:87], v[76:79]
    s_mov_b32 s56, 557056
    s_mov_b32 s57, 561152
    buffer_load_dwordx4 a[96:99], v2, s[12:15], s56 offen offset:0 nt
    buffer_load_dwordx4 a[100:103], v2, s[12:15], s56 offen offset:256 nt
    buffer_load_dwordx4 a[104:107], v2, s[12:15], s56 offen offset:2048 nt
    buffer_load_dwordx4 a[108:111], v2, s[12:15], s56 offen offset:2304 nt
    buffer_load_dwordx4 a[112:115], v2, s[12:15], s57 offen offset:0 nt
    buffer_load_dwordx4 a[116:119], v2, s[12:15], s57 offen offset:256 nt
    buffer_load_dwordx4 a[120:123], v2, s[12:15], s57 offen offset:2048 nt
    buffer_load_dwordx4 a[124:127], v2, s[12:15], s57 offen offset:2304 nt
    s_waitcnt vmcnt(24)
    v_and_b32_dpp v80, v54, v3 row_newbcast:0 row_mask:0xf bank_mask:0xf
    v_and_b32_dpp v81, v54, v4 row_newbcast:0 row_mask:0xf bank_mask:0xf
    v_and_b32_dpp v82, v54, v5 row_newbcast:0 row_mask:0xf bank_mask:0xf
    v_and_b32_dpp v83, v54, v6 row_newbcast:0 row_mask:0xf bank_mask:0xf
    v_and_b32_dpp v84, v54, v3 row_newbcast:4 row_mask:0xf bank_mask:0xf
    v_and_b32_dpp v85, v54, v4 row_newbcast:4 row_mask:0xf bank_mask:0xf
    v_and_b32_dpp v86, v54, v5 row_newbcast:4 row_mask:0xf bank_mask:0xf
    v_and_b32_dpp v87, v54, v6 row_newbcast:4 row_mask:0xf bank_mask:0xf
    v_mfma_f32_16x16x32_bf16 v[72:75], a[0:3], v[80:83], v[72:75]
    v_mfma_f32_16x16x32_bf16 v[76:79], a[4:7], v[80:83], v[76:79]
    v_and_b32_dpp v80, v54, v3 row_newbcast:8 row_mask:0xf bank_mask:0xf
    v_and_b32_dpp v81, v54, v4 row_newbcast:8 row_mask:0xf bank_mask:0xf
    v_and_b32_dpp v82, v54, v5 row_newbcast:8 row_mask:0xf bank_mask:0xf
    v_and_b32_dpp v83, v54, v6 row_newbcast:8 row_mask:0xf bank_mask:0xf
    v_mfma_f32_16x16x32_bf16 v[72:75], a[8:11], v[84:87], v[72:75]
    v_mfma_f32_16x16x32_bf16 v[76:79], a[12:15], v[84:87], v[76:79]
    v_and_b32_dpp v84, v54, v3 row_newbcast:12 row_mask:0xf bank_mask:0xf
    v_and_b32_dpp v85, v54, v4 row_newbcast:12 row_mask:0xf bank_mask:0xf
    v_and_b32_dpp v86, v54, v5 row_newbcast:12 row_mask:0xf bank_mask:0xf
    v_and_b32_dpp v87, v54, v6 row_newbcast:12 row_mask:0xf bank_mask:0xf
    v_mfma_f32_16x16x32_bf16 v[72:75], a[16:19], v[80:83], v[72:75]
    v_mfma_f32_16x16x32_bf16 v[76:79], a[20:23], v[80:83], v[76:79]
    s_nop 1
    v_mfma_f32_16x16x32_bf16 v[72:75], a[24:27], v[84:87], v[72:75]
    v_mfma_f32_16x16x32_bf16 v[76:79], a[28:31], v[84:87], v[76:79]
    s_mov_b32 s56, 589824
    s_mov_b32 s57, 593920
    buffer_load_dwordx4 a[128:131], v2, s[12:15], s56 offen offset:0 nt
    buffer_load_dwordx4 a[132:135], v2, s[12:15], s56 offen offset:256 nt
    buffer_load_dwordx4 a[136:139], v2, s[12:15], s56 offen offset:2048 nt
    buffer_load_dwordx4 a[140:143], v2, s[12:15], s56 offen offset:2304 nt
    buffer_load_dwordx4 a[144:147], v2, s[12:15], s57 offen offset:0 nt
    buffer_load_dwordx4 a[148:151], v2, s[12:15], s57 offen offset:256 nt
    buffer_load_dwordx4 a[152:155], v2, s[12:15], s57 offen offset:2048 nt
    buffer_load_dwordx4 a[156:159], v2, s[12:15], s57 offen offset:2304 nt
    s_waitcnt vmcnt(24)
    v_and_b32_dpp v80, v55, v3 row_newbcast:0 row_mask:0xf bank_mask:0xf
    v_and_b32_dpp v81, v55, v4 row_newbcast:0 row_mask:0xf bank_mask:0xf
    v_and_b32_dpp v82, v55, v5 row_newbcast:0 row_mask:0xf bank_mask:0xf
    v_and_b32_dpp v83, v55, v6 row_newbcast:0 row_mask:0xf bank_mask:0xf
    v_and_b32_dpp v84, v55, v3 row_newbcast:4 row_mask:0xf bank_mask:0xf
    v_and_b32_dpp v85, v55, v4 row_newbcast:4 row_mask:0xf bank_mask:0xf
    v_and_b32_dpp v86, v55, v5 row_newbcast:4 row_mask:0xf bank_mask:0xf
    v_and_b32_dpp v87, v55, v6 row_newbcast:4 row_mask:0xf bank_mask:0xf
    v_mfma_f32_16x16x32_bf16 v[72:75], a[32:35], v[80:83], v[72:75]
    v_mfma_f32_16x16x32_bf16 v[76:79], a[36:39], v[80:83], v[76:79]
    v_and_b32_dpp v80, v55, v3 row_newbcast:8 row_mask:0xf bank_mask:0xf
    v_and_b32_dpp v81, v55, v4 row_newbcast:8 row_mask:0xf bank_mask:0xf
    v_and_b32_dpp v82, v55, v5 row_newbcast:8 row_mask:0xf bank_mask:0xf
    v_and_b32_dpp v83, v55, v6 row_newbcast:8 row_mask:0xf bank_mask:0xf
    v_mfma_f32_16x16x32_bf16 v[72:75], a[40:43], v[84:87], v[72:75]
    v_mfma_f32_16x16x32_bf16 v[76:79], a[44:47], v[84:87], v[76:79]
    v_and_b32_dpp v84, v55, v3 row_newbcast:12 row_mask:0xf bank_mask:0xf
    v_and_b32_dpp v85, v55, v4 row_newbcast:12 row_mask:0xf bank_mask:0xf
    v_and_b32_dpp v86, v55, v5 row_newbcast:12 row_mask:0xf bank_mask:0xf
    v_and_b32_dpp v87, v55, v6 row_newbcast:12 row_mask:0xf bank_mask:0xf
    v_mfma_f32_16x16x32_bf16 v[72:75], a[48:51], v[80:83], v[72:75]
    v_mfma_f32_16x16x32_bf16 v[76:79], a[52:55], v[80:83], v[76:79]
    s_nop 1
    v_mfma_f32_16x16x32_bf16 v[72:75], a[56:59], v[84:87], v[72:75]
    v_mfma_f32_16x16x32_bf16 v[76:79], a[60:63], v[84:87], v[76:79]
    s_mov_b32 s56, 622592
    s_mov_b32 s57, 626688
    buffer_load_dwordx4 a[160:163], v2, s[12:15], s56 offen offset:0 nt
    buffer_load_dwordx4 a[164:167], v2, s[12:15], s56 offen offset:256 nt
    buffer_load_dwordx4 a[168:171], v2, s[12:15], s56 offen offset:2048 nt
    buffer_load_dwordx4 a[172:175], v2, s[12:15], s56 offen offset:2304 nt
    buffer_load_dwordx4 a[176:179], v2, s[12:15], s57 offen offset:0 nt
    buffer_load_dwordx4 a[180:183], v2, s[12:15], s57 offen offset:256 nt
    buffer_load_dwordx4 a[184:187], v2, s[12:15], s57 offen offset:2048 nt
    buffer_load_dwordx4 a[188:191], v2, s[12:15], s57 offen offset:2304 nt
    s_waitcnt vmcnt(24)
    v_and_b32_dpp v80, v56, v3 row_newbcast:0 row_mask:0xf bank_mask:0xf
    v_and_b32_dpp v81, v56, v4 row_newbcast:0 row_mask:0xf bank_mask:0xf
    v_and_b32_dpp v82, v56, v5 row_newbcast:0 row_mask:0xf bank_mask:0xf
    v_and_b32_dpp v83, v56, v6 row_newbcast:0 row_mask:0xf bank_mask:0xf
    v_and_b32_dpp v84, v56, v3 row_newbcast:4 row_mask:0xf bank_mask:0xf
    v_and_b32_dpp v85, v56, v4 row_newbcast:4 row_mask:0xf bank_mask:0xf
    v_and_b32_dpp v86, v56, v5 row_newbcast:4 row_mask:0xf bank_mask:0xf
    v_and_b32_dpp v87, v56, v6 row_newbcast:4 row_mask:0xf bank_mask:0xf
    v_mfma_f32_16x16x32_bf16 v[72:75], a[64:67], v[80:83], v[72:75]
    v_mfma_f32_16x16x32_bf16 v[76:79], a[68:71], v[80:83], v[76:79]
    v_and_b32_dpp v80, v56, v3 row_newbcast:8 row_mask:0xf bank_mask:0xf
    v_and_b32_dpp v81, v56, v4 row_newbcast:8 row_mask:0xf bank_mask:0xf
    v_and_b32_dpp v82, v56, v5 row_newbcast:8 row_mask:0xf bank_mask:0xf
    v_and_b32_dpp v83, v56, v6 row_newbcast:8 row_mask:0xf bank_mask:0xf
    v_mfma_f32_16x16x32_bf16 v[72:75], a[72:75], v[84:87], v[72:75]
    v_mfma_f32_16x16x32_bf16 v[76:79], a[76:79], v[84:87], v[76:79]
    v_and_b32_dpp v84, v56, v3 row_newbcast:12 row_mask:0xf bank_mask:0xf
    v_and_b32_dpp v85, v56, v4 row_newbcast:12 row_mask:0xf bank_mask:0xf
    v_and_b32_dpp v86, v56, v5 row_newbcast:12 row_mask:0xf bank_mask:0xf
    v_and_b32_dpp v87, v56, v6 row_newbcast:12 row_mask:0xf bank_mask:0xf
    v_mfma_f32_16x16x32_bf16 v[72:75], a[80:83], v[80:83], v[72:75]
    v_mfma_f32_16x16x32_bf16 v[76:79], a[84:87], v[80:83], v[76:79]
    s_nop 1
    v_mfma_f32_16x16x32_bf16 v[72:75], a[88:91], v[84:87], v[72:75]
    v_mfma_f32_16x16x32_bf16 v[76:79], a[92:95], v[84:87], v[76:79]
    s_mov_b32 s56, 655360
    s_mov_b32 s57, 659456
    buffer_load_dwordx4 a[192:195], v2, s[12:15], s56 offen offset:0 nt
    buffer_load_dwordx4 a[196:199], v2, s[12:15], s56 offen offset:256 nt
    buffer_load_dwordx4 a[200:203], v2, s[12:15], s56 offen offset:2048 nt
    buffer_load_dwordx4 a[204:207], v2, s[12:15], s56 offen offset:2304 nt
    buffer_load_dwordx4 a[208:211], v2, s[12:15], s57 offen offset:0 nt
    buffer_load_dwordx4 a[212:215], v2, s[12:15], s57 offen offset:256 nt
    buffer_load_dwordx4 a[216:219], v2, s[12:15], s57 offen offset:2048 nt
    buffer_load_dwordx4 a[220:223], v2, s[12:15], s57 offen offset:2304 nt
    s_waitcnt vmcnt(24)
    v_and_b32_dpp v80, v57, v3 row_newbcast:0 row_mask:0xf bank_mask:0xf
    v_and_b32_dpp v81, v57, v4 row_newbcast:0 row_mask:0xf bank_mask:0xf
    v_and_b32_dpp v82, v57, v5 row_newbcast:0 row_mask:0xf bank_mask:0xf
    v_and_b32_dpp v83, v57, v6 row_newbcast:0 row_mask:0xf bank_mask:0xf
    v_and_b32_dpp v84, v57, v3 row_newbcast:4 row_mask:0xf bank_mask:0xf
    v_and_b32_dpp v85, v57, v4 row_newbcast:4 row_mask:0xf bank_mask:0xf
    v_and_b32_dpp v86, v57, v5 row_newbcast:4 row_mask:0xf bank_mask:0xf
    v_and_b32_dpp v87, v57, v6 row_newbcast:4 row_mask:0xf bank_mask:0xf
    v_mfma_f32_16x16x32_bf16 v[72:75], a[96:99], v[80:83], v[72:75]
    v_mfma_f32_16x16x32_bf16 v[76:79], a[100:103], v[80:83], v[76:79]
    v_and_b32_dpp v80, v57, v3 row_newbcast:8 row_mask:0xf bank_mask:0xf
    v_and_b32_dpp v81, v57, v4 row_newbcast:8 row_mask:0xf bank_mask:0xf
    v_and_b32_dpp v82, v57, v5 row_newbcast:8 row_mask:0xf bank_mask:0xf
    v_and_b32_dpp v83, v57, v6 row_newbcast:8 row_mask:0xf bank_mask:0xf
    v_mfma_f32_16x16x32_bf16 v[72:75], a[104:107], v[84:87], v[72:75]
    v_mfma_f32_16x16x32_bf16 v[76:79], a[108:111], v[84:87], v[76:79]
    v_and_b32_dpp v84, v57, v3 row_newbcast:12 row_mask:0xf bank_mask:0xf
    v_and_b32_dpp v85, v57, v4 row_newbcast:12 row_mask:0xf bank_mask:0xf
    v_and_b32_dpp v86, v57, v5 row_newbcast:12 row_mask:0xf bank_mask:0xf
    v_and_b32_dpp v87, v57, v6 row_newbcast:12 row_mask:0xf bank_mask:0xf
    v_mfma_f32_16x16x32_bf16 v[72:75], a[112:115], v[80:83], v[72:75]
    v_mfma_f32_16x16x32_bf16 v[76:79], a[116:119], v[80:83], v[76:79]
    s_nop 1
    v_mfma_f32_16x16x32_bf16 v[72:75], a[120:123], v[84:87], v[72:75]
    v_mfma_f32_16x16x32_bf16 v[76:79], a[124:127], v[84:87], v[76:79]
    buffer_load_dwordx4 a[224:227], v2, s[12:15], s83 offen offset:0 nt
    buffer_load_dwordx4 a[228:231], v2, s[12:15], s83 offen offset:256 nt
    s_mov_b64 exec, s[84:85]
    buffer_load_dwordx4 a[232:235], v2, s[12:15], s83 offen offset:2048 nt
    buffer_load_dwordx4 a[236:239], v2, s[12:15], s83 offen offset:2304 nt
    s_mov_b64 exec, -1
    s_waitcnt vmcnt(20)
    v_and_b32_dpp v80, v58, v3 row_newbcast:0 row_mask:0xf bank_mask:0xf
    v_and_b32_dpp v81, v58, v4 row_newbcast:0 row_mask:0xf bank_mask:0xf
    v_and_b32_dpp v82, v58, v5 row_newbcast:0 row_mask:0xf bank_mask:0xf
    v_and_b32_dpp v83, v58, v6 row_newbcast:0 row_mask:0xf bank_mask:0xf
    v_and_b32_dpp v84, v58, v3 row_newbcast:4 row_mask:0xf bank_mask:0xf
    v_and_b32_dpp v85, v58, v4 row_newbcast:4 row_mask:0xf bank_mask:0xf
    v_and_b32_dpp v86, v58, v5 row_newbcast:4 row_mask:0xf bank_mask:0xf
    v_and_b32_dpp v87, v58, v6 row_newbcast:4 row_mask:0xf bank_mask:0xf
    v_mfma_f32_16x16x32_bf16 v[72:75], a[128:131], v[80:83], v[72:75]
    v_mfma_f32_16x16x32_bf16 v[76:79], a[132:135], v[80:83], v[76:79]
    v_and_b32_dpp v80, v58, v3 row_newbcast:8 row_mask:0xf bank_mask:0xf
    v_and_b32_dpp v81, v58, v4 row_newbcast:8 row_mask:0xf bank_mask:0xf
    v_and_b32_dpp v82, v58, v5 row_newbcast:8 row_mask:0xf bank_mask:0xf
    v_and_b32_dpp v83, v58, v6 row_newbcast:8 row_mask:0xf bank_mask:0xf
    v_mfma_f32_16x16x32_bf16 v[72:75], a[136:139], v[84:87], v[72:75]
    v_mfma_f32_16x16x32_bf16 v[76:79], a[140:143], v[84:87], v[76:79]
    v_and_b32_dpp v84, v58, v3 row_newbcast:12 row_mask:0xf bank_mask:0xf
    v_and_b32_dpp v85, v58, v4 row_newbcast:12 row_mask:0xf bank_mask:0xf
    v_and_b32_dpp v86, v58, v5 row_newbcast:12 row_mask:0xf bank_mask:0xf
    v_and_b32_dpp v87, v58, v6 row_newbcast:12 row_mask:0xf bank_mask:0xf
    v_mfma_f32_16x16x32_bf16 v[72:75], a[144:147], v[80:83], v[72:75]
    v_mfma_f32_16x16x32_bf16 v[76:79], a[148:151], v[80:83], v[76:79]
    s_nop 1
    v_mfma_f32_16x16x32_bf16 v[72:75], a[152:155], v[84:87], v[72:75]
    v_mfma_f32_16x16x32_bf16 v[76:79], a[156:159], v[84:87], v[76:79]
    s_cmp_lg_u32 s3, 0
    s_cbranch_scc1 L_nohead_6
    s_lshl_b32 s5, s2, 6
    s_add_u32 s5, s5, 4104
    v_mov_b32 v88, s44
    v_mov_b32 v89, s44
    v_mov_b32 v90, 0
    s_mov_b64 exec, 1
    buffer_store_dwordx2 v[88:89], v90, s[52:55], s5 offen sc1
    s_mov_b64 exec, -1
L_nohead_6:
    s_waitcnt vmcnt(12)
    v_and_b32_dpp v80, v59, v3 row_newbcast:0 row_mask:0xf bank_mask:0xf
    v_and_b32_dpp v81, v59, v4 row_newbcast:0 row_mask:0xf bank_mask:0xf
    v_and_b32_dpp v82, v59, v5 row_newbcast:0 row_mask:0xf bank_mask:0xf
    v_and_b32_dpp v83, v59, v6 row_newbcast:0 row_mask:0xf bank_mask:0xf
    v_and_b32_dpp v84, v59, v3 row_newbcast:4 row_mask:0xf bank_mask:0xf
    v_and_b32_dpp v85, v59, v4 row_newbcast:4 row_mask:0xf bank_mask:0xf
    v_and_b32_dpp v86, v59, v5 row_newbcast:4 row_mask:0xf bank_mask:0xf
    v_and_b32_dpp v87, v59, v6 row_newbcast:4 row_mask:0xf bank_mask:0xf
    v_mfma_f32_16x16x32_bf16 v[72:75], a[160:163], v[80:83], v[72:75]
    v_mfma_f32_16x16x32_bf16 v[76:79], a[164:167], v[80:83], v[76:79]
    v_and_b32_dpp v80, v59, v3 row_newbcast:8 row_mask:0xf bank_mask:0xf
    v_and_b32_dpp v81, v59, v4 row_newbcast:8 row_mask:0xf bank_mask:0xf
    v_and_b32_dpp v82, v59, v5 row_newbcast:8 row_mask:0xf bank_mask:0xf
    v_and_b32_dpp v83, v59, v6 row_newbcast:8 row_mask:0xf bank_mask:0xf
    v_mfma_f32_16x16x32_bf16 v[72:75], a[168:171], v[84:87], v[72:75]
    v_mfma_f32_16x16x32_bf16 v[76:79], a[172:175], v[84:87], v[76:79]
    v_and_b32_dpp v84, v59, v3 row_newbcast:12 row_mask:0xf bank_mask:0xf
    v_and_b32_dpp v85, v59, v4 row_newbcast:12 row_mask:0xf bank_mask:0xf
    v_and_b32_dpp v86, v59, v5 row_newbcast:12 row_mask:0xf bank_mask:0xf
    v_and_b32_dpp v87, v59, v6 row_newbcast:12 row_mask:0xf bank_mask:0xf
    v_mfma_f32_16x16x32_bf16 v[72:75], a[176:179], v[80:83], v[72:75]
    v_mfma_f32_16x16x32_bf16 v[76:79], a[180:183], v[80:83], v[76:79]
    s_nop 1
    v_mfma_f32_16x16x32_bf16 v[72:75], a[184:187], v[84:87], v[72:75]
    v_mfma_f32_16x16x32_bf16 v[76:79], a[188:191], v[84:87], v[76:79]
    s_cmp_lg_u32 s3, 0
    s_cbranch_scc1 L_nohead_7
    s_lshl_b32 s5, s2, 6
    s_add_u32 s5, s5, 4096
    v_mov_b32 v88, s44
    v_mov_b32 v89, s44
    v_mov_b32 v90, 0
    s_mov_b64 exec, 1
    buffer_store_dwordx2 v[88:89], v90, s[52:55], s5 offen sc1
    s_mov_b64 exec, -1
L_nohead_7:
    s_waitcnt vmcnt(4)
    v_and_b32_dpp v80, v60, v3 row_newbcast:0 row_mask:0xf bank_mask:0xf
    v_and_b32_dpp v81, v60, v4 row_newbcast:0 row_mask:0xf bank_mask:0xf
    v_and_b32_dpp v82, v60, v5 row_newbcast:0 row_mask:0xf bank_mask:0xf
    v_and_b32_dpp v83, v60, v6 row_newbcast:0 row_mask:0xf bank_mask:0xf
    v_and_b32_dpp v84, v60, v3 row_newbcast:4 row_mask:0xf bank_mask:0xf
    v_and_b32_dpp v85, v60, v4 row_newbcast:4 row_mask:0xf bank_mask:0xf
    v_and_b32_dpp v86, v60, v5 row_newbcast:4 row_mask:0xf bank_mask:0xf
    v_and_b32_dpp v87, v60, v6 row_newbcast:4 row_mask:0xf bank_mask:0xf
    v_mfma_f32_16x16x32_bf16 v[72:75], a[192:195], v[80:83], v[72:75]
    v_mfma_f32_16x16x32_bf16 v[76:79], a[196:199], v[80:83], v[76:79]
    v_and_b32_dpp v80, v60, v3 row_newbcast:8 row_mask:0xf bank_mask:0xf
    v_and_b32_dpp v81, v60, v4 row_newbcast:8 row_mask:0xf bank_mask:0xf
    v_and_b32_dpp v82, v60, v5 row_newbcast:8 row_mask:0xf bank_mask:0xf
    v_and_b32_dpp v83, v60, v6 row_newbcast:8 row_mask:0xf bank_mask:0xf
    v_mfma_f32_16x16x32_bf16 v[72:75], a[200:203], v[84:87], v[72:75]
    v_mfma_f32_16x16x32_bf16 v[76:79], a[204:207], v[84:87], v[76:79]
    v_and_b32_dpp v84, v60, v3 row_newbcast:12 row_mask:0xf bank_mask:0xf
    v_and_b32_dpp v85, v60, v4 row_newbcast:12 row_mask:0xf bank_mask:0xf
    v_and_b32_dpp v86, v60, v5 row_newbcast:12 row_mask:0xf bank_mask:0xf
    v_and_b32_dpp v87, v60, v6 row_newbcast:12 row_mask:0xf bank_mask:0xf
    v_mfma_f32_16x16x32_bf16 v[72:75], a[208:211], v[80:83], v[72:75]
    v_mfma_f32_16x16x32_bf16 v[76:79], a[212:215], v[80:83], v[76:79]
    s_nop 1
    v_mfma_f32_16x16x32_bf16 v[72:75], a[216:219], v[84:87], v[72:75]
    v_mfma_f32_16x16x32_bf16 v[76:79], a[220:223], v[84:87], v[76:79]
    s_waitcnt vmcnt(0)
    v_and_b32_dpp v80, v61, v3 row_newbcast:0 row_mask:0xf bank_mask:0xf
    v_and_b32_dpp v81, v61, v4 row_newbcast:0 row_mask:0xf bank_mask:0xf
    v_and_b32_dpp v82, v61, v5 row_newbcast:0 row_mask:0xf bank_mask:0xf
    v_and_b32_dpp v83, v61, v6 row_newbcast:0 row_mask:0xf bank_mask:0xf
    v_and_b32_dpp v84, v61, v3 row_newbcast:4 row_mask:0xf bank_mask:0xf
    v_and_b32_dpp v85, v61, v4 row_newbcast:4 row_mask:0xf bank_mask:0xf
    v_and_b32_dpp v86, v61, v5 row_newbcast:4 row_mask:0xf bank_mask:0xf
    v_and_b32_dpp v87, v61, v6 row_newbcast:4 row_mask:0xf bank_mask:0xf
    v_mfma_f32_16x16x32_bf16 v[72:75], a[224:227], v[80:83], v[72:75]
    v_mfma_f32_16x16x32_bf16 v[76:79], a[228:231], v[80:83], v[76:79]
    s_nop 1
    v_mfma_f32_16x16x32_bf16 v[72:75], a[232:235], v[84:87], v[72:75]
    v_mfma_f32_16x16x32_bf16 v[76:79], a[236:239], v[84:87], v[76:79]
    s_nop 7
    v_cndmask_b32 v90, v72, v76, s[66:67]
    v_cndmask_b32 v91, v73, v77, s[66:67]
    v_cndmask_b32 v92, v74, v78, s[66:67]
    v_cndmask_b32 v93, v75, v79, s[66:67]
    ds_write_b32 v114, v90 offset:0
    ds_write_b32 v114, v91 offset:32
    ds_write_b32 v114, v92 offset:64
    ds_write_b32 v114, v93 offset:96
    s_mov_b64 exec, 1
    ds_write_b64 v115, v[62:63] offset:4096
    s_mov_b64 exec, -1
    s_waitcnt lgkmcnt(0)
    s_barrier
    ds_read_b128 v[96:99], v119 offset:4096
    ds_read_b128 v[100:103], v119 offset:4112
    ds_read_b32 v104, v120 offset:0
    ds_read_b32 v105, v120 offset:1024
    ds_read_b32 v106, v120 offset:2048
    ds_read_b32 v107, v120 offset:3072
    s_waitcnt lgkmcnt(4)
    v_max_f32 v91, v96, v98
    v_max3_f32 v91, v100, v102, v91
    v_sub_f32 v96, v96, v91
    v_sub_f32 v98, v98, v91
    v_sub_f32 v100, v100, v91
    v_sub_f32 v102, v102, v91
    v_exp_f32 v96, v96
    v_exp_f32 v98, v98
    v_exp_f32 v100, v100
    v_exp_f32 v102, v102
    s_nop 0
    v_mul_f32 v92, v96, v97
    v_fmac_f32 v92, v98, v99
    v_fmac_f32 v92, v100, v101
    v_fmac_f32 v92, v102, v103
    v_rcp_f32 v93, v92
    v_log_f32 v92, v92
    s_waitcnt lgkmcnt(0)
    v_mul_f32 v108, v96, v104
    v_fmac_f32 v108, v98, v105
    v_fmac_f32 v108, v100, v106
    v_fmac_f32 v108, v102, v107
    v_add_f32 v110, v91, v92
    v_mul_f32 v108, v108, v93
    buffer_store_dwordx4 v[108:111], v121, s[52:55], s86 offen sc1
    s_endpgm
L_helper0:
    s_load_dwordx16 s[16:31], s[0:1], 0
    s_load_dwordx8 s[32:39], s[0:1], 64
    s_load_dwordx4 s[40:43], s[0:1], 96
    v_lshlrev_b32 v3, 7, v0
    s_getpc_b64 s[46:47]
L_pc_8:
    s_sub_u32 s46, s46, L_pc_8-adaLN_cond__mha_block_cached__glu_gated_glu__decode_kernel
    s_subb_u32 s47, s47, 0
    s_mov_b32 s6, L_codeend-adaLN_cond__mha_block_cached__glu_gated_glu__decode_kernel
    v_cmp_gt_u32 vcc, s6, v3
    s_nop 0
    s_and_b64 exec, exec, vcc
    s_cbranch_execz L_nopf_9
    global_load_dword v31, v3, s[46:47]
L_nopf_9:
    s_mov_b64 exec, -1
    v_lshrrev_b32 v1, 6, v0
    v_and_b32 v0, 63, v0
    s_nop 0
    v_readfirstlane_b32 s3, v1
    v_mov_b32 v2, 0
    s_waitcnt lgkmcnt(0)
    s_mov_b32 s52, s42
    s_mov_b32 s53, s43
    s_mov_b32 s54, 2097152
    s_mov_b32 s55, 0x20000
    buffer_load_dword v1, v2, s[52:55], 0 offen sc1
L_helper:
    s_sub_u32 s4, s2, 192
    s_mov_b32 s64, 0x05040100
    s_mov_b32 s65, 0x07060302
    v_lshlrev_b32 v16, 4, v0
    v_lshlrev_b32 v24, 5, v0
    s_and_b32 s74, s3, 1
    s_mul_i32 s6, s74, 896
    s_mov_b32 s48, s34
    s_mov_b32 s49, s35
    s_mov_b32 s50, 1792
    s_mov_b32 s51, 0x20000
    s_mov_b32 s8, s16
    s_mov_b32 s9, s17
    s_mov_b32 s10, 1792
    s_mov_b32 s11, 0x20000
    s_mov_b32 exec_lo, -1
    s_mov_b32 exec_hi, 0x00ffffff
    buffer_load_dwordx4 v[144:147], v16, s[48:51], s6 offen
    buffer_load_dwordx4 v[148:151], v16, s[8:11], s6 offen
    s_mov_b64 exec, -1
    v_lshrrev_b32 v2, 3, v0
    v_and_b32 v2, 1, v2
    v_lshrrev_b32 v3, 4, v0
    v_lshlrev_b32 v4, 5, v2
    v_lshl_add_u32 v4, v3, 3, v4
    s_lshl_b32 s5, s3, 6
    v_add_u32 v4, s5, v4
    v_and_b32 v5, 7, v0
    v_lshlrev_b32 v5, 4, v5
    s_mov_b32 s5, 5376
    v_mul_lo_u32 v17, v4, s5
    v_add_u32 v17, v17, v5
    v_lshl_add_u32 v18, v4, 13, v5
    s_sub_u32 s86, s4, 50
    s_cmp_lt_u32 s4, 50
    s_cbranch_scc1 L_nomload_10
    s_lshl_b32 s7, s86, 7
    s_sub_u32 s75, 2408448, s7
    s_add_u32 s8, s36, s7
    s_addc_u32 s9, s37, 0
    s_mov_b32 s10, s75
    s_mov_b32 s11, 0x20000
    s_mov_b32 s5, 0
    buffer_load_dwordx4 v[64:67], v17, s[8:11], s5 offen nt
    s_mov_b32 s5, 5376
    buffer_load_dwordx4 v[68:71], v17, s[8:11], s5 offen nt
    s_mov_b32 s5, 10752
    buffer_load_dwordx4 v[72:75], v17, s[8:11], s5 offen nt
    s_mov_b32 s5, 16128
    buffer_load_dwordx4 v[76:79], v17, s[8:11], s5 offen nt
    s_mov_b32 s5, 21504
    buffer_load_dwordx4 v[80:83], v17, s[8:11], s5 offen nt
    s_mov_b32 s5, 26880
    buffer_load_dwordx4 v[84:87], v17, s[8:11], s5 offen nt
    s_mov_b32 s5, 32256
    buffer_load_dwordx4 v[88:91], v17, s[8:11], s5 offen nt
    s_mov_b32 s5, 37632
    buffer_load_dwordx4 v[92:95], v17, s[8:11], s5 offen nt
    s_mov_b32 s5, 1376256
    buffer_load_dwordx4 v[96:99], v17, s[8:11], s5 offen nt
    s_mov_b32 s5, 1381632
    buffer_load_dwordx4 v[100:103], v17, s[8:11], s5 offen nt
    s_mov_b32 s5, 1387008
    buffer_load_dwordx4 v[104:107], v17, s[8:11], s5 offen nt
    s_mov_b32 s5, 1392384
    buffer_load_dwordx4 v[108:111], v17, s[8:11], s5 offen nt
    s_mov_b32 s5, 1397760
    buffer_load_dwordx4 v[112:115], v17, s[8:11], s5 offen nt
    s_mov_b32 s5, 1403136
    buffer_load_dwordx4 v[116:119], v17, s[8:11], s5 offen nt
    s_mov_b32 s5, 1408512
    buffer_load_dwordx4 v[120:123], v17, s[8:11], s5 offen nt
    s_mov_b32 s5, 1413888
    buffer_load_dwordx4 v[124:127], v17, s[8:11], s5 offen nt
    s_branch L_nomload_b_11
L_nomload_10:
    s_lshl_b32 s7, s4, 7
    s_sub_u32 s75, 3670016, s7
    s_add_u32 s12, s22, s7
    s_addc_u32 s13, s23, 0
    s_mov_b32 s14, s75
    s_mov_b32 s15, 0x20000
    s_mov_b32 s5, 0
    buffer_load_dwordx4 v[192:195], v18, s[12:15], s5 offen nt
    s_mov_b32 s5, 8192
    buffer_load_dwordx4 v[196:199], v18, s[12:15], s5 offen nt
    s_mov_b32 s5, 16384
    buffer_load_dwordx4 v[200:203], v18, s[12:15], s5 offen nt
    s_mov_b32 s5, 24576
    buffer_load_dwordx4 v[204:207], v18, s[12:15], s5 offen nt
    s_mov_b32 s5, 32768
    buffer_load_dwordx4 v[208:211], v18, s[12:15], s5 offen nt
    s_mov_b32 s5, 40960
    buffer_load_dwordx4 v[212:215], v18, s[12:15], s5 offen nt
    s_mov_b32 s5, 49152
    buffer_load_dwordx4 v[216:219], v18, s[12:15], s5 offen nt
    s_mov_b32 s5, 57344
    buffer_load_dwordx4 v[220:223], v18, s[12:15], s5 offen nt
    s_mov_b32 s5, 2097152
    buffer_load_dwordx4 v[224:227], v18, s[12:15], s5 offen nt
    s_mov_b32 s5, 2105344
    buffer_load_dwordx4 v[228:231], v18, s[12:15], s5 offen nt
    s_mov_b32 s5, 2113536
    buffer_load_dwordx4 v[232:235], v18, s[12:15], s5 offen nt
    s_mov_b32 s5, 2121728
    buffer_load_dwordx4 v[236:239], v18, s[12:15], s5 offen nt
    s_mov_b32 s5, 2129920
    buffer_load_dwordx4 v[240:243], v18, s[12:15], s5 offen nt
    s_mov_b32 s5, 2138112
    buffer_load_dwordx4 v[244:247], v18, s[12:15], s5 offen nt
    s_mov_b32 s5, 2146304
    buffer_load_dwordx4 v[248:251], v18, s[12:15], s5 offen nt
    s_mov_b32 s5, 2154496
    buffer_load_dwordx4 v[252:255], v18, s[12:15], s5 offen nt
L_nomload_b_11:
    v_lshrrev_b32 v5, 2, v0
    v_and_b32 v5, 1, v5
    v_mul_u32_u24 v19, 1152, v5
    v_lshl_add_u32 v19, v2, 6, v19
    v_lshl_add_u32 v19, v3, 4, v19
    s_lshl_b32 s5, s3, 7
    v_add_u32 v19, s5, v19
    s_lshl_b32 s5, s3, 11
    s_add_u32 s5, s5, 5376
    v_lshlrev_b32 v20, 2, v0
    v_add_u32 v20, s5, v20
    v_and_b32 v6, 3, v0
    v_lshlrev_b32 v21, 9, v6
    v_lshrrev_b32 v6, 5, v0
    v_lshl_add_u32 v21, v6, 6, v21
    v_lshrrev_b32 v6, 2, v0
    v_and_b32 v6, 7, v6
    v_lshl_add_u32 v21, v6, 2, v21
    v_add_u32 v21, 5376, v21
    v_add_u32 v22, 160, v21
    s_mul_i32 s5, s74, 1152
    v_add_u32 v23, s5, v16
    s_waitcnt vmcnt(16)
    v_readfirstlane_b32 s44, v1
    s_nop 3
    s_mul_i32 s44, s44, 0x19660d
    s_add_u32 s44, s44, 0x3c6ef35f
    s_cmp_ge_u32 s3, 2
    s_cbranch_scc1 L_noln1_12
    v_cmp_gt_u32 vcc, 56, v0
    s_nop 1
    v_cndmask_b32 v144, 0, v144, vcc
    v_cndmask_b32 v145, 0, v145, vcc
    v_cndmask_b32 v146, 0, v146, vcc
    v_cndmask_b32 v147, 0, v147, vcc
    v_cndmask_b32 v148, 0, v148, vcc
    v_cndmask_b32 v149, 0, v149, vcc
    v_cndmask_b32 v150, 0, v150, vcc
    v_cndmask_b32 v151, 0, v151, vcc
    v_lshlrev_b32 v168, 16, v144
    v_and_b32 v169, 0xffff0000, v144
    v_lshlrev_b32 v170, 16, v145
    v_and_b32 v171, 0xffff0000, v145
    v_lshlrev_b32 v172, 16, v146
    v_and_b32 v173, 0xffff0000, v146
    v_lshlrev_b32 v174, 16, v147
    v_and_b32 v175, 0xffff0000, v147
    s_mov_b32 s5, 0xbfb8aa3b
    v_mul_f32 v176, s5, v168
    v_mul_f32 v177, s5, v169
    v_mul_f32 v178, s5, v170
    v_mul_f32 v179, s5, v171
    v_mul_f32 v180, s5, v172
    v_mul_f32 v181, s5, v173
    v_mul_f32 v182, s5, v174
    v_mul_f32 v183, s5, v175
    v_exp_f32 v176, v176
    v_exp_f32 v177, v177
    v_exp_f32 v178, v178
    v_exp_f32 v179, v179
    v_exp_f32 v180, v180
    v_exp_f32 v181, v181
    v_exp_f32 v182, v182
    v_exp_f32 v183, v183
    s_nop 0
    v_add_f32 v176, 1.0, v176
    v_add_f32 v177, 1.0, v177
    v_add_f32 v178, 1.0, v178
    v_add_f32 v179, 1.0, v179
    v_add_f32 v180, 1.0, v180
    v_add_f32 v181, 1.0, v181
    v_add_f32 v182, 1.0, v182
    v_add_f32 v183, 1.0, v183
    v_rcp_f32 v176, v176
    v_rcp_f32 v177, v177
    v_rcp_f32 v178, v178
    v_rcp_f32 v179, v179
    v_rcp_f32 v180, v180
    v_rcp_f32 v181, v181
    v_rcp_f32 v182, v182
    v_rcp_f32 v183, v183
    s_nop 0
    v_mul_f32 v176, v176, v168
    v_mul_f32 v177, v177, v169
    v_mul_f32 v178, v178, v170
    v_mul_f32 v179, v179, v171
    v_mul_f32 v180, v180, v172
    v_mul_f32 v181, v181, v173
    v_mul_f32 v182, v182, v174
    v_mul_f32 v183, v183, v175
    v_cvt_pk_bf16_f32 v2, v176, v177
    v_cvt_pk_bf16_f32 v3, v178, v179
    v_cvt_pk_bf16_f32 v4, v180, v181
    v_cvt_pk_bf16_f32 v5, v182, v183
    s_mov_b32 exec_lo, -1
    s_mov_b32 exec_hi, 0x00ffffff
    ds_write_b128 v23, v[2:5] offset:0
    s_mov_b64 exec, -1
    v_lshlrev_b32 v168, 16, v148
    v_and_b32 v169, 0xffff0000, v148
    v_lshlrev_b32 v170, 16, v149
    v_and_b32 v171, 0xffff0000, v149
    v_lshlrev_b32 v172, 16, v150
    v_and_b32 v173, 0xffff0000, v150
    v_lshlrev_b32 v174, 16, v151
    v_and_b32 v175, 0xffff0000, v151
    v_readfirstlane_b32 s7, v168
    v_cmp_gt_u32 vcc, 56, v0
    s_nop 0
    v_mov_b32 v8, s7
    v_pk_add_f32 v[160:161], v[168:169], v[8:9] op_sel_hi:[1,0] neg_lo:[0,1] neg_hi:[0,1]
    v_pk_add_f32 v[162:163], v[170:171], v[8:9] op_sel_hi:[1,0] neg_lo:[0,1] neg_hi:[0,1]
    v_pk_add_f32 v[164:165], v[172:173], v[8:9] op_sel_hi:[1,0] neg_lo:[0,1] neg_hi:[0,1]
    v_pk_add_f32 v[166:167], v[174:175], v[8:9] op_sel_hi:[1,0] neg_lo:[0,1] neg_hi:[0,1]
    v_pk_add_f32 v[2:3], v[160:161], v[162:163]
    v_pk_mul_f32 v[4:5], v[160:161], v[160:161]
    v_pk_add_f32 v[6:7], v[164:165], v[166:167]
    v_pk_fma_f32 v[4:5], v[162:163], v[162:163], v[4:5]
    v_pk_add_f32 v[2:3], v[2:3], v[6:7]
    v_pk_fma_f32 v[4:5], v[164:165], v[164:165], v[4:5]
    v_add_f32 v2, v2, v3
    v_pk_fma_f32 v[4:5], v[166:167], v[166:167], v[4:5]
    v_cndmask_b32 v2, 0, v2, vcc
    v_add_f32 v4, v4, v5
    v_cndmask_b32 v4, 0, v4, vcc
    s_nop 0
    v_add_f32_dpp v2, v2, v2 row_shr:1 row_mask:0xf bank_mask:0xf bound_ctrl:0
    v_add_f32_dpp v4, v4, v4 row_shr:1 row_mask:0xf bank_mask:0xf bound_ctrl:0
    s_nop 0
    v_add_f32_dpp v2, v2, v2 row_shr:2 row_mask:0xf bank_mask:0xf bound_ctrl:0
    v_add_f32_dpp v4, v4, v4 row_shr:2 row_mask:0xf bank_mask:0xf bound_ctrl:0
    s_nop 0
    v_add_f32_dpp v2, v2, v2 row_shr:4 row_mask:0xf bank_mask:0xf bound_ctrl:0
    v_add_f32_dpp v4, v4, v4 row_shr:4 row_mask:0xf bank_mask:0xf bound_ctrl:0
    s_nop 0
    v_add_f32_dpp v2, v2, v2 row_shr:8 row_mask:0xf bank_mask:0xf bound_ctrl:0
    v_add_f32_dpp v4, v4, v4 row_shr:8 row_mask:0xf bank_mask:0xf bound_ctrl:0
    s_nop 0
    v_add_f32_dpp v2, v2, v2 row_bcast:15 row_mask:0xa bank_mask:0xf
    v_add_f32_dpp v4, v4, v4 row_bcast:15 row_mask:0xa bank_mask:0xf
    s_nop 0
    v_add_f32_dpp v2, v2, v2 row_bcast:31 row_mask:0xc bank_mask:0xf
    v_add_f32_dpp v4, v4, v4 row_bcast:31 row_mask:0xc bank_mask:0xf
    s_nop 0
    v_readlane_b32 s84, v2, 63
    v_readlane_b32 s85, v4, 63
    v_mov_b32 v6, 0x3b124925
    s_nop 0
    v_mul_f32 v2, s84, v6
    v_mul_f32 v4, s85, v6
    v_fma_f32 v4, -v2, v2, v4
    v_add_f32 v2, v2, v8
    v_max_f32 v4, 0, v4
    v_cvt_pk_bf16_f32 v6, v2, v4
    v_and_b32 v4, 0xffff0000, v6
    v_lshlrev_b32 v2, 16, v6
    v_add_f32 v4, 0x3727c5ac, v4
    v_pk_add_f32 v[160:161], v[168:169], v[2:3] op_sel_hi:[1,0] neg_lo:[0,1] neg_hi:[0,1]
    v_pk_add_f32 v[162:163], v[170:171], v[2:3] op_sel_hi:[1,0] neg_lo:[0,1] neg_hi:[0,1]
    v_cvt_pk_bf16_f32 v4, v4, v4
    v_pk_add_f32 v[164:165], v[172:173], v[2:3] op_sel_hi:[1,0] neg_lo:[0,1] neg_hi:[0,1]
    v_pk_add_f32 v[166:167], v[174:175], v[2:3] op_sel_hi:[1,0] neg_lo:[0,1] neg_hi:[0,1]
    v_lshlrev_b32 v4, 16, v4
    v_sqrt_f32 v4, v4
    v_cvt_pk_bf16_f32 v6, v160, v161
    v_lshlrev_b32 v160, 16, v6
    v_and_b32 v161, 0xffff0000, v6
    v_cvt_pk_bf16_f32 v6, v162, v163
    v_lshlrev_b32 v162, 16, v6
    v_and_b32 v163, 0xffff0000, v6
    v_cvt_pk_bf16_f32 v4, v4, v4
    v_lshlrev_b32 v4, 16, v4
    v_rcp_f32 v4, v4
    v_cvt_pk_bf16_f32 v6, v164, v165
    v_lshlrev_b32 v164, 16, v6
    v_and_b32 v165, 0xffff0000, v6
    v_cvt_pk_bf16_f32 v6, v166, v167
    v_lshlrev_b32 v166, 16, v6
    v_and_b32 v167, 0xffff0000, v6
    v_pk_mul_f32 v[160:161], v[160:161], v[4:5] op_sel_hi:[1,0]
    v_pk_mul_f32 v[162:163], v[162:163], v[4:5] op_sel_hi:[1,0]
    v_pk_mul_f32 v[164:165], v[164:165], v[4:5] op_sel_hi:[1,0]
    v_pk_mul_f32 v[166:167], v[166:167], v[4:5] op_sel_hi:[1,0]
    v_cvt_pk_bf16_f32 v6, v160, v161
    v_lshlrev_b32 v160, 16, v6
    v_and_b32 v161, 0xffff0000, v6
    v_cvt_pk_bf16_f32 v6, v162, v163
    v_lshlrev_b32 v162, 16, v6
    v_and_b32 v163, 0xffff0000, v6
    v_cvt_pk_bf16_f32 v6, v164, v165
    v_lshlrev_b32 v164, 16, v6
    v_and_b32 v165, 0xffff0000, v6
    v_cvt_pk_bf16_f32 v6, v166, v167
    v_lshlrev_b32 v166, 16, v6
    v_and_b32 v167, 0xffff0000, v6
L_noln1_12:
    s_waitcnt lgkmcnt(0)
    s_barrier
    s_cmp_lt_u32 s4, 50
    s_cbranch_scc1 L_nom_13
    ds_read_b128 v[6:9], v19 offset:0
    ds_read_b128 v[10:13], v19 offset:512
    s_waitcnt vmcnt(8)
    v_perm_b32 v128, v68, v64, s64
    v_perm_b32 v129, v76, v72, s64
    v_perm_b32 v130, v84, v80, s64
    v_perm_b32 v131, v92, v88, s64
    v_perm_b32 v132, v68, v64, s65
    v_perm_b32 v133, v76, v72, s65
    v_perm_b32 v134, v84, v80, s65
    v_perm_b32 v135, v92, v88, s65
    v_perm_b32 v136, v69, v65, s64
    v_perm_b32 v137, v77, v73, s64
    v_perm_b32 v138, v85, v81, s64
    v_perm_b32 v139, v93, v89, s64
    v_perm_b32 v140, v69, v65, s65
    v_perm_b32 v141, v77, v73, s65
    v_perm_b32 v142, v85, v81, s65
    v_perm_b32 v143, v93, v89, s65
    v_perm_b32 v144, v70, v66, s64
    v_perm_b32 v145, v78, v74, s64
    v_perm_b32 v146, v86, v82, s64
    v_perm_b32 v147, v94, v90, s64
    v_perm_b32 v148, v70, v66, s65
    v_perm_b32 v149, v78, v74, s65
    v_perm_b32 v150, v86, v82, s65
    v_perm_b32 v151, v94, v90, s65
    v_perm_b32 v152, v71, v67, s64
    v_perm_b32 v153, v79, v75, s64
    v_perm_b32 v154, v87, v83, s64
    v_perm_b32 v155, v95, v91, s64
    v_perm_b32 v156, v71, v67, s65
    v_perm_b32 v157, v79, v75, s65
    v_perm_b32 v158, v87, v83, s65
    v_perm_b32 v159, v95, v91, s65
    s_waitcnt lgkmcnt(0)
    s_nop 0
    v_mfma_f32_16x16x32_bf16 v[32:35], v[6:9], v[128:131], 0
    v_mfma_f32_16x16x32_bf16 v[36:39], v[6:9], v[132:135], 0
    v_mfma_f32_16x16x32_bf16 v[40:43], v[6:9], v[136:139], 0
    v_mfma_f32_16x16x32_bf16 v[44:47], v[6:9], v[140:143], 0
    v_mfma_f32_16x16x32_bf16 v[48:51], v[6:9], v[144:147], 0
    v_mfma_f32_16x16x32_bf16 v[52:55], v[6:9], v[148:151], 0
    v_mfma_f32_16x16x32_bf16 v[56:59], v[6:9], v[152:155], 0
    v_mfma_f32_16x16x32_bf16 v[60:63], v[6:9], v[156:159], 0
    s_cmp_eq_u32 s3, 3
    s_cbranch_scc1 L_m2_14
    s_waitcnt vmcnt(0)
    v_perm_b32 v128, v100, v96, s64
    v_perm_b32 v129, v108, v104, s64
    v_perm_b32 v130, v116, v112, s64
    v_perm_b32 v131, v124, v120, s64
    v_perm_b32 v132, v100, v96, s65
    v_perm_b32 v133, v108, v104, s65
    v_perm_b32 v134, v116, v112, s65
    v_perm_b32 v135, v124, v120, s65
    v_perm_b32 v136, v101, v97, s64
    v_perm_b32 v137, v109, v105, s64
    v_perm_b32 v138, v117, v113, s64
    v_perm_b32 v139, v125, v121, s64
    v_perm_b32 v140, v101, v97, s65
    v_perm_b32 v141, v109, v105, s65
    v_perm_b32 v142, v117, v113, s65
    v_perm_b32 v143, v125, v121, s65
    v_perm_b32 v144, v102, v98, s64
    v_perm_b32 v145, v110, v106, s64
    v_perm_b32 v146, v118, v114, s64
    v_perm_b32 v147, v126, v122, s64
    v_perm_b32 v148, v102, v98, s65
    v_perm_b32 v149, v110, v106, s65
    v_perm_b32 v150, v118, v114, s65
    v_perm_b32 v151, v126, v122, s65
    v_perm_b32 v152, v103, v99, s64
    v_perm_b32 v153, v111, v107, s64
    v_perm_b32 v154, v119, v115, s64
    v_perm_b32 v155, v127, v123, s64
    v_perm_b32 v156, v103, v99, s65
    v_perm_b32 v157, v111, v107, s65
    v_perm_b32 v158, v119, v115, s65
    v_perm_b32 v159, v127, v123, s65
    s_nop 1
    v_mfma_f32_16x16x32_bf16 v[32:35], v[10:13], v[128:131], v[32:35]
    v_mfma_f32_16x16x32_bf16 v[36:39], v[10:13], v[132:135], v[36:39]
    v_mfma_f32_16x16x32_bf16 v[40:43], v[10:13], v[136:139], v[40:43]
    v_mfma_f32_16x16x32_bf16 v[44:47], v[10:13], v[140:143], v[44:47]
    v_mfma_f32_16x16x32_bf16 v[48:51], v[10:13], v[144:147], v[48:51]
    v_mfma_f32_16x16x32_bf16 v[52:55], v[10:13], v[148:151], v[52:55]
    v_mfma_f32_16x16x32_bf16 v[56:59], v[10:13], v[152:155], v[56:59]
    v_mfma_f32_16x16x32_bf16 v[60:63], v[10:13], v[156:159], v[60:63]
L_m2_14:
    s_nop 7
    ds_write_b32 v20, v32 offset:0
    ds_write_b32 v20, v36 offset:256
    ds_write_b32 v20, v40 offset:512
    ds_write_b32 v20, v44 offset:768
    ds_write_b32 v20, v48 offset:1024
    ds_write_b32 v20, v52 offset:1280
    ds_write_b32 v20, v56 offset:1536
    ds_write_b32 v20, v60 offset:1792
    s_waitcnt lgkmcnt(0)
    s_barrier
    s_cmp_lg_u32 s3, 0
    s_cbranch_scc1 L_m3_15
    ds_read2st64_b32 v[128:129], v21 offset0:0 offset1:1
    ds_read2st64_b32 v[136:137], v22 offset0:0 offset1:1
    ds_read2st64_b32 v[130:131], v21 offset0:8 offset1:9
    ds_read2st64_b32 v[138:139], v22 offset0:8 offset1:9
    ds_read2st64_b32 v[132:133], v21 offset0:16 offset1:17
    ds_read2st64_b32 v[140:141], v22 offset0:16 offset1:17
    ds_read2st64_b32 v[134:135], v21 offset0:24 offset1:25
    ds_read2st64_b32 v[142:143], v22 offset0:24 offset1:25
    s_waitcnt lgkmcnt(0)
    v_add_f32 v128, v128, v130
    v_add_f32 v132, v132, v134
    v_add_f32 v129, v129, v131
    v_add_f32 v133, v133, v135
    v_add_f32 v128, v128, v132
    v_add_f32 v129, v129, v133
    v_add_f32 v136, v136, v138
    v_add_f32 v140, v140, v142
    v_add_f32 v137, v137, v139
    v_add_f32 v141, v141, v143
    v_add_f32 v136, v136, v140
    v_add_f32 v137, v137, v141
    v_add_f32 v128, v128, v136
    v_add_f32 v129, v129, v137
    v_cvt_pk_bf16_f32 v130, v128, v129
    v_mov_b32 v131, s44
    v_lshrrev_b32 v2, 5, v0
    v_mul_u32_u24 v2, 10752, v2
    v_and_b32 v3, 31, v0
    v_lshl_add_u32 v2, v3, 3, v2
    s_lshl_b32 s5, s86, 8
    s_add_u32 s5, s5, 16384
    buffer_store_dwordx2 v[130:131], v2, s[52:55], s5 offen sc1
L_m3_15:
    s_lshl_b32 s7, s4, 7
    s_sub_u32 s75, 3670016, s7
    s_add_u32 s12, s22, s7
    s_addc_u32 s13, s23, 0
    s_mov_b32 s14, s75
    s_mov_b32 s15, 0x20000
    s_mov_b32 s5, 0
    buffer_load_dwordx4 v[192:195], v18, s[12:15], s5 offen nt
    s_mov_b32 s5, 8192
    buffer_load_dwordx4 v[196:199], v18, s[12:15], s5 offen nt
    s_mov_b32 s5, 16384
    buffer_load_dwordx4 v[200:203], v18, s[12:15], s5 offen nt
    s_mov_b32 s5, 24576
    buffer_load_dwordx4 v[204:207], v18, s[12:15], s5 offen nt
    s_mov_b32 s5, 32768
    buffer_load_dwordx4 v[208:211], v18, s[12:15], s5 offen nt
    s_mov_b32 s5, 40960
    buffer_load_dwordx4 v[212:215], v18, s[12:15], s5 offen nt
    s_mov_b32 s5, 49152
    buffer_load_dwordx4 v[216:219], v18, s[12:15], s5 offen nt
    s_mov_b32 s5, 57344
    buffer_load_dwordx4 v[220:223], v18, s[12:15], s5 offen nt
    s_mov_b32 s5, 2097152
    buffer_load_dwordx4 v[224:227], v18, s[12:15], s5 offen nt
    s_mov_b32 s5, 2105344
    buffer_load_dwordx4 v[228:231], v18, s[12:15], s5 offen nt
    s_mov_b32 s5, 2113536
    buffer_load_dwordx4 v[232:235], v18, s[12:15], s5 offen nt
    s_mov_b32 s5, 2121728
    buffer_load_dwordx4 v[236:239], v18, s[12:15], s5 offen nt
    s_mov_b32 s5, 2129920
    buffer_load_dwordx4 v[240:243], v18, s[12:15], s5 offen nt
    s_mov_b32 s5, 2138112
    buffer_load_dwordx4 v[244:247], v18, s[12:15], s5 offen nt
    s_mov_b32 s5, 2146304
    buffer_load_dwordx4 v[248:251], v18, s[12:15], s5 offen nt
    s_mov_b32 s5, 2154496
    buffer_load_dwordx4 v[252:255], v18, s[12:15], s5 offen nt
L_nom_13:
    s_waitcnt vmcnt(8)
    v_perm_b32 v64, v196, v192, s64
    v_perm_b32 v65, v204, v200, s64
    v_perm_b32 v66, v212, v208, s64
    v_perm_b32 v67, v220, v216, s64
    v_perm_b32 v68, v196, v192, s65
    v_perm_b32 v69, v204, v200, s65
    v_perm_b32 v70, v212, v208, s65
    v_perm_b32 v71, v220, v216, s65
    v_perm_b32 v72, v197, v193, s64
    v_perm_b32 v73, v205, v201, s64
    v_perm_b32 v74, v213, v209, s64
    v_perm_b32 v75, v221, v217, s64
    v_perm_b32 v76, v197, v193, s65
    v_perm_b32 v77, v205, v201, s65
    v_perm_b32 v78, v213, v209, s65
    v_perm_b32 v79, v221, v217, s65
    v_perm_b32 v80, v198, v194, s64
    v_perm_b32 v81, v206, v202, s64
    v_perm_b32 v82, v214, v210, s64
    v_perm_b32 v83, v222, v218, s64
    v_perm_b32 v84, v198, v194, s65
    v_perm_b32 v85, v206, v202, s65
    v_perm_b32 v86, v214, v210, s65
    v_perm_b32 v87, v222, v218, s65
    v_perm_b32 v88, v199, v195, s64
    v_perm_b32 v89, v207, v203, s64
    v_perm_b32 v90, v215, v211, s64
    v_perm_b32 v91, v223, v219, s64
    v_perm_b32 v92, v199, v195, s65
    v_perm_b32 v93, v207, v203, s65
    v_perm_b32 v94, v215, v211, s65
    v_perm_b32 v95, v223, v219, s65
    s_waitcnt vmcnt(0)
    v_perm_b32 v96, v228, v224, s64
    v_perm_b32 v97, v236, v232, s64
    v_perm_b32 v98, v244, v240, s64
    v_perm_b32 v99, v252, v248, s64
    v_perm_b32 v100, v228, v224, s65
    v_perm_b32 v101, v236, v232, s65
    v_perm_b32 v102, v244, v240, s65
    v_perm_b32 v103, v252, v248, s65
    v_perm_b32 v104, v229, v225, s64
    v_perm_b32 v105, v237, v233, s64
    v_perm_b32 v106, v245, v241, s64
    v_perm_b32 v107, v253, v249, s64
    v_perm_b32 v108, v229, v225, s65
    v_perm_b32 v109, v237, v233, s65
    v_perm_b32 v110, v245, v241, s65
    v_perm_b32 v111, v253, v249, s65
    v_perm_b32 v112, v230, v226, s64
    v_perm_b32 v113, v238, v234, s64
    v_perm_b32 v114, v246, v242, s64
    v_perm_b32 v115, v254, v250, s64
    v_perm_b32 v116, v230, v226, s65
    v_perm_b32 v117, v238, v234, s65
    v_perm_b32 v118, v246, v242, s65
    v_perm_b32 v119, v254, v250, s65
    v_perm_b32 v120, v231, v227, s64
    v_perm_b32 v121, v239, v235, s64
    v_perm_b32 v122, v247, v243, s64
    v_perm_b32 v123, v255, v251, s64
    v_perm_b32 v124, v231, v227, s65
    v_perm_b32 v125, v239, v235, s65
    v_perm_b32 v126, v247, v243, s65
    v_perm_b32 v127, v255, v251, s65
    s_cmp_ge_u32 s3, 2
    s_cbranch_scc1 L_noh_16
    s_mul_i32 s77, s74, 10752
    s_add_u32 s77, s77, 16384
    s_mov_b32 exec_lo, -1
    s_mov_b32 exec_hi, 0x00ffffff
    s_mov_b32 s45, 0
L_poll_17:
    buffer_load_dwordx4 v[144:147], v24, s[52:55], s77 offen offset:0 sc1
    buffer_load_dwordx4 v[148:151], v24, s[52:55], s77 offen offset:16 sc1
    buffer_load_dwordx4 v[152:155], v24, s[52:55], s77 offen offset:1792 sc1
    buffer_load_dwordx4 v[156:159], v24, s[52:55], s77 offen offset:1808 sc1
    s_waitcnt vmcnt(0)
    v_xor_b32 v2, s44, v145
    v_xor_b32 v3, s44, v147
    v_or_b32 v2, v2, v3
    v_xor_b32 v3, s44, v149
    v_or_b32 v2, v2, v3
    v_xor_b32 v3, s44, v151
    v_or_b32 v2, v2, v3
    v_xor_b32 v3, s44, v153
    v_or_b32 v2, v2, v3
    v_xor_b32 v3, s44, v155
    v_or_b32 v2, v2, v3
    v_xor_b32 v3, s44, v157
    v_or_b32 v2, v2, v3
    v_xor_b32 v3, s44, v159
    v_or_b32 v2, v2, v3
    v_cmp_ne_u32 vcc, 0, v2
    s_nop 1
    s_cbranch_vccz L_pollok_18
    s_sleep 1
    s_add_u32 s45, s45, 1
    s_cmp_lt_u32 s45, 200000
    s_cbranch_scc1 L_poll_17
L_pollok_18:
    v_lshlrev_b32 v168, 16, v144
    v_and_b32 v169, 0xffff0000, v144
    v_lshlrev_b32 v170, 16, v146
    v_and_b32 v171, 0xffff0000, v146
    v_lshlrev_b32 v172, 16, v148
    v_and_b32 v173, 0xffff0000, v148
    v_lshlrev_b32 v174, 16, v150
    v_and_b32 v175, 0xffff0000, v150
    v_lshlrev_b32 v176, 16, v152
    v_and_b32 v177, 0xffff0000, v152
    v_lshlrev_b32 v178, 16, v154
    v_and_b32 v179, 0xffff0000, v154
    v_lshlrev_b32 v180, 16, v156
    v_and_b32 v181, 0xffff0000, v156
    v_lshlrev_b32 v182, 16, v158
    v_and_b32 v183, 0xffff0000, v158
    v_add_f32 v176, 1.0, v176
    v_add_f32 v177, 1.0, v177
    v_add_f32 v178, 1.0, v178
    v_add_f32 v179, 1.0, v179
    v_add_f32 v180, 1.0, v180
    v_add_f32 v181, 1.0, v181
    v_add_f32 v182, 1.0, v182
    v_add_f32 v183, 1.0, v183
    v_cvt_pk_bf16_f32 v2, v176, v177
    v_lshlrev_b32 v176, 16, v2
    v_and_b32 v177, 0xffff0000, v2
    v_cvt_pk_bf16_f32 v2, v178, v179
    v_lshlrev_b32 v178, 16, v2
    v_and_b32 v179, 0xffff0000, v2
    v_cvt_pk_bf16_f32 v2, v180, v181
    v_lshlrev_b32 v180, 16, v2
    v_and_b32 v181, 0xffff0000, v2
    v_cvt_pk_bf16_f32 v2, v182, v183
    v_lshlrev_b32 v182, 16, v2
    v_and_b32 v183, 0xffff0000, v2
    v_pk_mul_f32 v[160:161], v[160:161], v[176:177]
    v_pk_mul_f32 v[162:163], v[162:163], v[178:179]
    v_pk_mul_f32 v[164:165], v[164:165], v[180:181]
    v_pk_mul_f32 v[166:167], v[166:167], v[182:183]
    v_cvt_pk_bf16_f32 v2, v160, v161
    v_lshlrev_b32 v160, 16, v2
    v_and_b32 v161, 0xffff0000, v2
    v_cvt_pk_bf16_f32 v2, v162, v163
    v_lshlrev_b32 v162, 16, v2
    v_and_b32 v163, 0xffff0000, v2
    v_cvt_pk_bf16_f32 v2, v164, v165
    v_lshlrev_b32 v164, 16, v2
    v_and_b32 v165, 0xffff0000, v2
    v_cvt_pk_bf16_f32 v2, v166, v167
    v_lshlrev_b32 v166, 16, v2
    v_and_b32 v167, 0xffff0000, v2
    v_pk_add_f32 v[160:161], v[160:161], v[168:169]
    v_pk_add_f32 v[162:163], v[162:163], v[170:171]
    v_pk_add_f32 v[164:165], v[164:165], v[172:173]
    v_pk_add_f32 v[166:167], v[166:167], v[174:175]
    v_cvt_pk_bf16_f32 v2, v160, v161
    v_cvt_pk_bf16_f32 v3, v162, v163
    v_cvt_pk_bf16_f32 v4, v164, v165
    v_cvt_pk_bf16_f32 v5, v166, v167
    ds_write_b128 v23, v[2:5] offset:2304
    s_mov_b64 exec, -1
L_noh_16:
    s_waitcnt lgkmcnt(0)
    s_barrier
    ds_read_b128 v[6:9], v19 offset:2304
    ds_read_b128 v[10:13], v19 offset:2816
    s_waitcnt lgkmcnt(1)
    v_mfma_f32_16x16x32_bf16 v[32:35], v[6:9], v[64:67], 0
    v_mfma_f32_16x16x32_bf16 v[36:39], v[6:9], v[68:71], 0
    v_mfma_f32_16x16x32_bf16 v[40:43], v[6:9], v[72:75], 0
    v_mfma_f32_16x16x32_bf16 v[44:47], v[6:9], v[76:79], 0
    v_mfma_f32_16x16x32_bf16 v[48:51], v[6:9], v[80:83], 0
    v_mfma_f32_16x16x32_bf16 v[52:55], v[6:9], v[84:87], 0
    v_mfma_f32_16x16x32_bf16 v[56:59], v[6:9], v[88:91], 0
    v_mfma_f32_16x16x32_bf16 v[60:63], v[6:9], v[92:95], 0
    s_cmp_eq_u32 s3, 3
    s_cbranch_scc1 L_q2_19
    s_waitcnt lgkmcnt(0)
    v_mfma_f32_16x16x32_bf16 v[32:35], v[10:13], v[96:99], v[32:35]
    v_mfma_f32_16x16x32_bf16 v[36:39], v[10:13], v[100:103], v[36:39]
    v_mfma_f32_16x16x32_bf16 v[40:43], v[10:13], v[104:107], v[40:43]
    v_mfma_f32_16x16x32_bf16 v[44:47], v[10:13], v[108:111], v[44:47]
    v_mfma_f32_16x16x32_bf16 v[48:51], v[10:13], v[112:115], v[48:51]
    v_mfma_f32_16x16x32_bf16 v[52:55], v[10:13], v[116:119], v[52:55]
    v_mfma_f32_16x16x32_bf16 v[56:59], v[10:13], v[120:123], v[56:59]
    v_mfma_f32_16x16x32_bf16 v[60:63], v[10:13], v[124:127], v[60:63]
L_q2_19:
    s_waitcnt lgkmcnt(0)
    s_nop 7
    ds_write_b32 v20, v32 offset:0
    ds_write_b32 v20, v36 offset:256
    ds_write_b32 v20, v40 offset:512
    ds_write_b32 v20, v44 offset:768
    ds_write_b32 v20, v48 offset:1024
    ds_write_b32 v20, v52 offset:1280
    ds_write_b32 v20, v56 offset:1536
    ds_write_b32 v20, v60 offset:1792
    s_waitcnt lgkmcnt(0)
    s_barrier
    s_cmp_lg_u32 s3, 0
    s_cbranch_scc1 L_q3_20
    ds_read2st64_b32 v[128:129], v21 offset0:0 offset1:1
    ds_read2st64_b32 v[136:137], v22 offset0:0 offset1:1
    ds_read2st64_b32 v[130:131], v21 offset0:8 offset1:9
    ds_read2st64_b32 v[138:139], v22 offset0:8 offset1:9
    ds_read2st64_b32 v[132:133], v21 offset0:16 offset1:17
    ds_read2st64_b32 v[140:141], v22 offset0:16 offset1:17
    ds_read2st64_b32 v[134:135], v21 offset0:24 offset1:25
    ds_read2st64_b32 v[142:143], v22 offset0:24 offset1:25
    s_waitcnt lgkmcnt(0)
    v_add_f32 v128, v128, v130
    v_add_f32 v132, v132, v134
    v_add_f32 v129, v129, v131
    v_add_f32 v133, v133, v135
    v_add_f32 v128, v128, v132
    v_add_f32 v129, v129, v133
    v_add_f32 v136, v136, v138
    v_add_f32 v140, v140, v142
    v_add_f32 v137, v137, v139
    v_add_f32 v141, v141, v143
    v_add_f32 v136, v136, v140
    v_add_f32 v137, v137, v141
    v_add_f32 v128, v128, v136
    v_add_f32 v129, v129, v137
    v_cvt_pk_bf16_f32 v130, v128, v129
    v_mov_b32 v131, s44
    v_lshrrev_b32 v2, 5, v0
    v_lshlrev_b32 v2, 14, v2
    v_and_b32 v3, 31, v0
    v_lshl_add_u32 v2, v3, 3, v2
    s_lshl_b32 s5, s4, 8
    s_add_u32 s5, s5, 40960
    buffer_store_dwordx2 v[130:131], v2, s[52:55], s5 offen sc1
L_q3_20:
    s_cmp_ge_u32 s4, 32
    s_cbranch_scc1 L_rf
    s_cmp_lt_u32 s4, 4
    s_cbranch_scc1 L_nomrest_21
    s_add_u32 s86, s4, 10
    s_lshl_b32 s7, s86, 7
    s_sub_u32 s75, 2408448, s7
    s_add_u32 s8, s36, s7
    s_addc_u32 s9, s37, 0
    s_mov_b32 s10, s75
    s_mov_b32 s11, 0x20000
    s_mov_b32 s5, 0
    buffer_load_dwordx4 v[64:67], v17, s[8:11], s5 offen nt
    s_mov_b32 s5, 5376
    buffer_load_dwordx4 v[68:71], v17, s[8:11], s5 offen nt
    s_mov_b32 s5, 10752
    buffer_load_dwordx4 v[72:75], v17, s[8:11], s5 offen nt
    s_mov_b32 s5, 16128
    buffer_load_dwordx4 v[76:79], v17, s[8:11], s5 offen nt
    s_mov_b32 s5, 21504
    buffer_load_dwordx4 v[80:83], v17, s[8:11], s5 offen nt
    s_mov_b32 s5, 26880
    buffer_load_dwordx4 v[84:87], v17, s[8:11], s5 offen nt
    s_mov_b32 s5, 32256
    buffer_load_dwordx4 v[88:91], v17, s[8:11], s5 offen nt
    s_mov_b32 s5, 37632
    buffer_load_dwordx4 v[92:95], v17, s[8:11], s5 offen nt
    s_mov_b32 s5, 1376256
    buffer_load_dwordx4 v[96:99], v17, s[8:11], s5 offen nt
    s_mov_b32 s5, 1381632
    buffer_load_dwordx4 v[100:103], v17, s[8:11], s5 offen nt
    s_mov_b32 s5, 1387008
    buffer_load_dwordx4 v[104:107], v17, s[8:11], s5 offen nt
    s_mov_b32 s5, 1392384
    buffer_load_dwordx4 v[108:111], v17, s[8:11], s5 offen nt
    s_mov_b32 s5, 1397760
    buffer_load_dwordx4 v[112:115], v17, s[8:11], s5 offen nt
    s_mov_b32 s5, 1403136
    buffer_load_dwordx4 v[116:119], v17, s[8:11], s5 offen nt
    s_mov_b32 s5, 1408512
    buffer_load_dwordx4 v[120:123], v17, s[8:11], s5 offen nt
    s_mov_b32 s5, 1413888
    buffer_load_dwordx4 v[124:127], v17, s[8:11], s5 offen nt
    s_barrier
    ds_read_b128 v[6:9], v19 offset:0
    ds_read_b128 v[10:13], v19 offset:512
    s_waitcnt vmcnt(8)
    v_perm_b32 v128, v68, v64, s64
    v_perm_b32 v129, v76, v72, s64
    v_perm_b32 v130, v84, v80, s64
    v_perm_b32 v131, v92, v88, s64
    v_perm_b32 v132, v68, v64, s65
    v_perm_b32 v133, v76, v72, s65
    v_perm_b32 v134, v84, v80, s65
    v_perm_b32 v135, v92, v88, s65
    v_perm_b32 v136, v69, v65, s64
    v_perm_b32 v137, v77, v73, s64
    v_perm_b32 v138, v85, v81, s64
    v_perm_b32 v139, v93, v89, s64
    v_perm_b32 v140, v69, v65, s65
    v_perm_b32 v141, v77, v73, s65
    v_perm_b32 v142, v85, v81, s65
    v_perm_b32 v143, v93, v89, s65
    v_perm_b32 v144, v70, v66, s64
    v_perm_b32 v145, v78, v74, s64
    v_perm_b32 v146, v86, v82, s64
    v_perm_b32 v147, v94, v90, s64
    v_perm_b32 v148, v70, v66, s65
    v_perm_b32 v149, v78, v74, s65
    v_perm_b32 v150, v86, v82, s65
    v_perm_b32 v151, v94, v90, s65
    v_perm_b32 v152, v71, v67, s64
    v_perm_b32 v153, v79, v75, s64
    v_perm_b32 v154, v87, v83, s64
    v_perm_b32 v155, v95, v91, s64
    v_perm_b32 v156, v71, v67, s65
    v_perm_b32 v157, v79, v75, s65
    v_perm_b32 v158, v87, v83, s65
    v_perm_b32 v159, v95, v91, s65
    s_waitcnt lgkmcnt(0)
    s_nop 0
    v_mfma_f32_16x16x32_bf16 v[32:35], v[6:9], v[128:131], 0
    v_mfma_f32_16x16x32_bf16 v[36:39], v[6:9], v[132:135], 0
    v_mfma_f32_16x16x32_bf16 v[40:43], v[6:9], v[136:139], 0
    v_mfma_f32_16x16x32_bf16 v[44:47], v[6:9], v[140:143], 0
    v_mfma_f32_16x16x32_bf16 v[48:51], v[6:9], v[144:147], 0
    v_mfma_f32_16x16x32_bf16 v[52:55], v[6:9], v[148:151], 0
    v_mfma_f32_16x16x32_bf16 v[56:59], v[6:9], v[152:155], 0
    v_mfma_f32_16x16x32_bf16 v[60:63], v[6:9], v[156:159], 0
    s_cmp_eq_u32 s3, 3
    s_cbranch_scc1 L_m2_22
    s_waitcnt vmcnt(0)
    v_perm_b32 v128, v100, v96, s64
    v_perm_b32 v129, v108, v104, s64
    v_perm_b32 v130, v116, v112, s64
    v_perm_b32 v131, v124, v120, s64
    v_perm_b32 v132, v100, v96, s65
    v_perm_b32 v133, v108, v104, s65
    v_perm_b32 v134, v116, v112, s65
    v_perm_b32 v135, v124, v120, s65
    v_perm_b32 v136, v101, v97, s64
    v_perm_b32 v137, v109, v105, s64
    v_perm_b32 v138, v117, v113, s64
    v_perm_b32 v139, v125, v121, s64
    v_perm_b32 v140, v101, v97, s65
    v_perm_b32 v141, v109, v105, s65
    v_perm_b32 v142, v117, v113, s65
    v_perm_b32 v143, v125, v121, s65
    v_perm_b32 v144, v102, v98, s64
    v_perm_b32 v145, v110, v106, s64
    v_perm_b32 v146, v118, v114, s64
    v_perm_b32 v147, v126, v122, s64
    v_perm_b32 v148, v102, v98, s65
    v_perm_b32 v149, v110, v106, s65
    v_perm_b32 v150, v118, v114, s65
    v_perm_b32 v151, v126, v122, s65
    v_perm_b32 v152, v103, v99, s64
    v_perm_b32 v153, v111, v107, s64
    v_perm_b32 v154, v119, v115, s64
    v_perm_b32 v155, v127, v123, s64
    v_perm_b32 v156, v103, v99, s65
    v_perm_b32 v157, v111, v107, s65
    v_perm_b32 v158, v119, v115, s65
    v_perm_b32 v159, v127, v123, s65
    s_nop 1
    v_mfma_f32_16x16x32_bf16 v[32:35], v[10:13], v[128:131], v[32:35]
    v_mfma_f32_16x16x32_bf16 v[36:39], v[10:13], v[132:135], v[36:39]
    v_mfma_f32_16x16x32_bf16 v[40:43], v[10:13], v[136:139], v[40:43]
    v_mfma_f32_16x16x32_bf16 v[44:47], v[10:13], v[140:143], v[44:47]
    v_mfma_f32_16x16x32_bf16 v[48:51], v[10:13], v[144:147], v[48:51]
    v_mfma_f32_16x16x32_bf16 v[52:55], v[10:13], v[148:151], v[52:55]
    v_mfma_f32_16x16x32_bf16 v[56:59], v[10:13], v[152:155], v[56:59]
    v_mfma_f32_16x16x32_bf16 v[60:63], v[10:13], v[156:159], v[60:63]
L_m2_22:
    s_nop 7
    ds_write_b32 v20, v32 offset:0
    ds_write_b32 v20, v36 offset:256
    ds_write_b32 v20, v40 offset:512
    ds_write_b32 v20, v44 offset:768
    ds_write_b32 v20, v48 offset:1024
    ds_write_b32 v20, v52 offset:1280
    ds_write_b32 v20, v56 offset:1536
    ds_write_b32 v20, v60 offset:1792
    s_waitcnt lgkmcnt(0)
    s_barrier
    s_cmp_lg_u32 s3, 0
    s_cbranch_scc1 L_m3_23
    ds_read2st64_b32 v[128:129], v21 offset0:0 offset1:1
    ds_read2st64_b32 v[136:137], v22 offset0:0 offset1:1
    ds_read2st64_b32 v[130:131], v21 offset0:8 offset1:9
    ds_read2st64_b32 v[138:139], v22 offset0:8 offset1:9
    ds_read2st64_b32 v[132:133], v21 offset0:16 offset1:17
    ds_read2st64_b32 v[140:141], v22 offset0:16 offset1:17
    ds_read2st64_b32 v[134:135], v21 offset0:24 offset1:25
    ds_read2st64_b32 v[142:143], v22 offset0:24 offset1:25
    s_waitcnt lgkmcnt(0)
    v_add_f32 v128, v128, v130
    v_add_f32 v132, v132, v134
    v_add_f32 v129, v129, v131
    v_add_f32 v133, v133, v135
    v_add_f32 v128, v128, v132
    v_add_f32 v129, v129, v133
    v_add_f32 v136, v136, v138
    v_add_f32 v140, v140, v142
    v_add_f32 v137, v137, v139
    v_add_f32 v141, v141, v143
    v_add_f32 v136, v136, v140
    v_add_f32 v137, v137, v141
    v_add_f32 v128, v128, v136
    v_add_f32 v129, v129, v137
    v_cvt_pk_bf16_f32 v130, v128, v129
    v_mov_b32 v131, s44
    v_lshrrev_b32 v2, 5, v0
    v_mul_u32_u24 v2, 10752, v2
    v_and_b32 v3, 31, v0
    v_lshl_add_u32 v2, v3, 3, v2
    s_lshl_b32 s5, s86, 8
    s_add_u32 s5, s5, 16384
    buffer_store_dwordx2 v[130:131], v2, s[52:55], s5 offen sc1
L_m3_23:
L_nomrest_21:
    s_mul_i32 s7, s4, 114688
    s_sub_u32 s75, 3670016, s7
    s_add_u32 s8, s24, s7
    s_addc_u32 s9, s25, 0
    s_mov_b32 s10, s75
    s_mov_b32 s11, 0x20000
    v_lshrrev_b32 v2, 4, v0
    v_mul_u32_u24 v17, 7168, v2
    v_and_b32 v2, 15, v0
    v_lshl_add_u32 v17, v2, 4, v17
    s_lshl_b32 s5, s3, 8
    v_add_u32 v17, s5, v17
    s_cmp_eq_u32 s3, 3
    s_cselect_b32 exec_lo, 0x00ff00ff, -1
    s_cselect_b32 exec_hi, 0x00ff00ff, -1
    s_mov_b32 s5, 0
    buffer_load_dwordx4 v[192:195], v17, s[8:11], s5 offen nt
    s_mov_b32 s5, 896
    buffer_load_dwordx4 v[196:199], v17, s[8:11], s5 offen nt
    s_mov_b32 s5, 1792
    buffer_load_dwordx4 v[200:203], v17, s[8:11], s5 offen nt
    s_mov_b32 s5, 2688
    buffer_load_dwordx4 v[204:207], v17, s[8:11], s5 offen nt
    s_mov_b32 s5, 3584
    buffer_load_dwordx4 v[208:211], v17, s[8:11], s5 offen nt
    s_mov_b32 s5, 4480
    buffer_load_dwordx4 v[212:215], v17, s[8:11], s5 offen nt
    s_mov_b32 s5, 5376
    buffer_load_dwordx4 v[216:219], v17, s[8:11], s5 offen nt
    s_mov_b32 s5, 6272
    buffer_load_dwordx4 v[220:223], v17, s[8:11], s5 offen nt
    s_mov_b64 exec, -1
    s_cmp_eq_u32 s3, 3
    s_cselect_b32 exec_lo, 0x00ff00ff, -1
    s_cselect_b32 exec_hi, 0x00ff00ff, -1
    s_mov_b32 s5, 28672
    buffer_load_dwordx4 v[224:227], v17, s[8:11], s5 offen nt
    s_mov_b32 s5, 29568
    buffer_load_dwordx4 v[228:231], v17, s[8:11], s5 offen nt
    s_mov_b32 s5, 30464
    buffer_load_dwordx4 v[232:235], v17, s[8:11], s5 offen nt
    s_mov_b32 s5, 31360
    buffer_load_dwordx4 v[236:239], v17, s[8:11], s5 offen nt
    s_mov_b32 s5, 32256
    buffer_load_dwordx4 v[240:243], v17, s[8:11], s5 offen nt
    s_mov_b32 s5, 33152
    buffer_load_dwordx4 v[244:247], v17, s[8:11], s5 offen nt
    s_mov_b32 s5, 34048
    buffer_load_dwordx4 v[248:251], v17, s[8:11], s5 offen nt
    s_mov_b32 s5, 34944
    buffer_load_dwordx4 v[252:255], v17, s[8:11], s5 offen nt
    s_mov_b64 exec, -1
    s_waitcnt vmcnt(8)
    v_perm_b32 v64, v196, v192, s64
    v_perm_b32 v65, v204, v200, s64
    v_perm_b32 v66, v212, v208, s64
    v_perm_b32 v67, v220, v216, s64
    v_perm_b32 v68, v196, v192, s65
    v_perm_b32 v69, v204, v200, s65
    v_perm_b32 v70, v212, v208, s65
    v_perm_b32 v71, v220, v216, s65
    v_perm_b32 v72, v197, v193, s64
    v_perm_b32 v73, v205, v201, s64
    v_perm_b32 v74, v213, v209, s64
    v_perm_b32 v75, v221, v217, s64
    v_perm_b32 v76, v197, v193, s65
    v_perm_b32 v77, v205, v201, s65
    v_perm_b32 v78, v213, v209, s65
    v_perm_b32 v79, v221, v217, s65
    v_perm_b32 v80, v198, v194, s64
    v_perm_b32 v81, v206, v202, s64
    v_perm_b32 v82, v214, v210, s64
    v_perm_b32 v83, v222, v218, s64
    v_perm_b32 v84, v198, v194, s65
    v_perm_b32 v85, v206, v202, s65
    v_perm_b32 v86, v214, v210, s65
    v_perm_b32 v87, v222, v218, s65
    v_perm_b32 v88, v199, v195, s64
    v_perm_b32 v89, v207, v203, s64
    v_perm_b32 v90, v215, v211, s64
    v_perm_b32 v91, v223, v219, s64
    v_perm_b32 v92, v199, v195, s65
    v_perm_b32 v93, v207, v203, s65
    v_perm_b32 v94, v215, v211, s65
    v_perm_b32 v95, v223, v219, s65
    s_cmp_eq_u32 s3, 3
    s_cselect_b32 exec_lo, 0x00ff00ff, -1
    s_cselect_b32 exec_hi, 0x00ff00ff, -1
    s_mov_b32 s5, 57344
    buffer_load_dwordx4 v[192:195], v17, s[8:11], s5 offen nt
    s_mov_b32 s5, 58240
    buffer_load_dwordx4 v[196:199], v17, s[8:11], s5 offen nt
    s_mov_b32 s5, 59136
    buffer_load_dwordx4 v[200:203], v17, s[8:11], s5 offen nt
    s_mov_b32 s5, 60032
    buffer_load_dwordx4 v[204:207], v17, s[8:11], s5 offen nt
    s_mov_b32 s5, 60928
    buffer_load_dwordx4 v[208:211], v17, s[8:11], s5 offen nt
    s_mov_b32 s5, 61824
    buffer_load_dwordx4 v[212:215], v17, s[8:11], s5 offen nt
    s_mov_b32 s5, 62720
    buffer_load_dwordx4 v[216:219], v17, s[8:11], s5 offen nt
    s_mov_b32 s5, 63616
    buffer_load_dwordx4 v[220:223], v17, s[8:11], s5 offen nt
    s_mov_b64 exec, -1
    s_waitcnt vmcnt(8)
    v_perm_b32 v96, v228, v224, s64
    v_perm_b32 v97, v236, v232, s64
    v_perm_b32 v98, v244, v240, s64
    v_perm_b32 v99, v252, v248, s64
    v_perm_b32 v100, v228, v224, s65
    v_perm_b32 v101, v236, v232, s65
    v_perm_b32 v102, v244, v240, s65
    v_perm_b32 v103, v252, v248, s65
    v_perm_b32 v104, v229, v225, s64
    v_perm_b32 v105, v237, v233, s64
    v_perm_b32 v106, v245, v241, s64
    v_perm_b32 v107, v253, v249, s64
    v_perm_b32 v108, v229, v225, s65
    v_perm_b32 v109, v237, v233, s65
    v_perm_b32 v110, v245, v241, s65
    v_perm_b32 v111, v253, v249, s65
    v_perm_b32 v112, v230, v226, s64
    v_perm_b32 v113, v238, v234, s64
    v_perm_b32 v114, v246, v242, s64
    v_perm_b32 v115, v254, v250, s64
    v_perm_b32 v116, v230, v226, s65
    v_perm_b32 v117, v238, v234, s65
    v_perm_b32 v118, v246, v242, s65
    v_perm_b32 v119, v254, v250, s65
    v_perm_b32 v120, v231, v227, s64
    v_perm_b32 v121, v239, v235, s64
    v_perm_b32 v122, v247, v243, s64
    v_perm_b32 v123, v255, v251, s64
    v_perm_b32 v124, v231, v227, s65
    v_perm_b32 v125, v239, v235, s65
    v_perm_b32 v126, v247, v243, s65
    v_perm_b32 v127, v255, v251, s65
    s_cmp_eq_u32 s3, 3
    s_cselect_b32 exec_lo, 0x00ff00ff, -1
    s_cselect_b32 exec_hi, 0x00ff00ff, -1
    s_mov_b32 s5, 86016
    buffer_load_dwordx4 v[224:227], v17, s[8:11], s5 offen nt
    s_mov_b32 s5, 86912
    buffer_load_dwordx4 v[228:231], v17, s[8:11], s5 offen nt
    s_mov_b32 s5, 87808
    buffer_load_dwordx4 v[232:235], v17, s[8:11], s5 offen nt
    s_mov_b32 s5, 88704
    buffer_load_dwordx4 v[236:239], v17, s[8:11], s5 offen nt
    s_mov_b32 s5, 89600
    buffer_load_dwordx4 v[240:243], v17, s[8:11], s5 offen nt
    s_mov_b32 s5, 90496
    buffer_load_dwordx4 v[244:247], v17, s[8:11], s5 offen nt
    s_mov_b32 s5, 91392
    buffer_load_dwordx4 v[248:251], v17, s[8:11], s5 offen nt
    s_mov_b32 s5, 92288
    buffer_load_dwordx4 v[252:255], v17, s[8:11], s5 offen nt
    s_mov_b64 exec, -1
    s_waitcnt vmcnt(8)
    v_perm_b32 v128, v196, v192, s64
    v_perm_b32 v129, v204, v200, s64
    v_perm_b32 v130, v212, v208, s64
    v_perm_b32 v131, v220, v216, s64
    v_perm_b32 v132, v196, v192, s65
    v_perm_b32 v133, v204, v200, s65
    v_perm_b32 v134, v212, v208, s65
    v_perm_b32 v135, v220, v216, s65
    v_perm_b32 v136, v197, v193, s64
    v_perm_b32 v137, v205, v201, s64
    v_perm_b32 v138, v213, v209, s64
    v_perm_b32 v139, v221, v217, s64
    v_perm_b32 v140, v197, v193, s65
    v_perm_b32 v141, v205, v201, s65
    v_perm_b32 v142, v213, v209, s65
    v_perm_b32 v143, v221, v217, s65
    v_perm_b32 v144, v198, v194, s64
    v_perm_b32 v145, v206, v202, s64
    v_perm_b32 v146, v214, v210, s64
    v_perm_b32 v147, v222, v218, s64
    v_perm_b32 v148, v198, v194, s65
    v_perm_b32 v149, v206, v202, s65
    v_perm_b32 v150, v214, v210, s65
    v_perm_b32 v151, v222, v218, s65
    v_perm_b32 v152, v199, v195, s64
    v_perm_b32 v153, v207, v203, s64
    v_perm_b32 v154, v215, v211, s64
    v_perm_b32 v155, v223, v219, s64
    v_perm_b32 v156, v199, v195, s65
    v_perm_b32 v157, v207, v203, s65
    v_perm_b32 v158, v215, v211, s65
    v_perm_b32 v159, v223, v219, s65
    s_waitcnt vmcnt(0)
    v_perm_b32 v160, v228, v224, s64
    v_perm_b32 v161, v236, v232, s64
    v_perm_b32 v162, v244, v240, s64
    v_perm_b32 v163, v252, v248, s64
    v_perm_b32 v164, v228, v224, s65
    v_perm_b32 v165, v236, v232, s65
    v_perm_b32 v166, v244, v240, s65
    v_perm_b32 v167, v252, v248, s65
    v_perm_b32 v168, v229, v225, s64
    v_perm_b32 v169, v237, v233, s64
    v_perm_b32 v170, v245, v241, s64
    v_perm_b32 v171, v253, v249, s64
    v_perm_b32 v172, v229, v225, s65
    v_perm_b32 v173, v237, v233, s65
    v_perm_b32 v174, v245, v241, s65
    v_perm_b32 v175, v253, v249, s65
    v_perm_b32 v176, v230, v226, s64
    v_perm_b32 v177, v238, v234, s64
    v_perm_b32 v178, v246, v242, s64
    v_perm_b32 v179, v254, v250, s64
    v_perm_b32 v180, v230, v226, s65
    v_perm_b32 v181, v238, v234, s65
    v_perm_b32 v182, v246, v242, s65
    v_perm_b32 v183, v254, v250, s65
    v_perm_b32 v184, v231, v227, s64
    v_perm_b32 v185, v239, v235, s64
    v_perm_b32 v186, v247, v243, s64
    v_perm_b32 v187, v255, v251, s64
    v_perm_b32 v188, v231, v227, s65
    v_perm_b32 v189, v239, v235, s65
    v_perm_b32 v190, v247, v243, s65
    v_perm_b32 v191, v255, v251, s65
    s_and_b32 s80, s4, 1
    s_lshr_b32 s5, s4, 3
    s_lshl_b32 s5, s5, 7
    s_lshr_b32 s6, s4, 1
    s_and_b32 s6, s6, 3
    s_lshl_b32 s6, s6, 1
    s_add_u32 s81, s5, s6
    v_and_b32 v2, 15, v0
    v_lshlrev_b32 v26, 3, v2
    v_add_u32 v26, s81, v26
    v_lshrrev_b32 v3, 4, v0
    v_lshlrev_b32 v25, 13, v3
    v_lshl_add_u32 v25, v2, 4, v25
    v_cmp_gt_u32 vcc, 448, v26
    s_mov_b64 s[66:67], vcc
    s_cmp_lg_u32 s3, 0
    s_cbranch_scc1 L_nor0_24
    s_mov_b64 exec, s[66:67]
    s_mov_b32 s12, s16
    s_mov_b32 s13, s17
    s_mov_b32 s14, 1792
    s_mov_b32 s15, 0x20000
    s_mul_i32 s5, s80, 896
    v_lshlrev_b32 v4, 1, v26
    buffer_load_dword v8, v4, s[12:15], s5 offen
    s_mul_i32 s82, s80, 10752
    s_add_u32 s82, s82, 19968
    s_add_u32 s83, s82, 5376
    v_lshlrev_b32 v5, 2, v26
    s_mov_b32 s45, 0
L_poll_25:
    buffer_load_dwordx2 v[10:11], v5, s[52:55], s82 offen sc1
    buffer_load_dwordx2 v[12:13], v5, s[52:55], s83 offen sc1
    s_waitcnt vmcnt(0)
    v_xor_b32 v2, s44, v11
    v_xor_b32 v3, s44, v13
    v_or_b32 v2, v2, v3
    v_cmp_ne_u32 vcc, 0, v2
    s_nop 1
    s_cbranch_vccz L_pollok_26
    s_sleep 4
    s_add_u32 s45, s45, 1
    s_cmp_lt_u32 s45, 200000
    s_cbranch_scc1 L_poll_25
L_pollok_26:
    v_mov_b32 v19, v8
    v_mov_b32 v22, v10
    v_mov_b32 v23, v12
    s_mov_b64 exec, -1
L_nor0_24:
    s_mov_b32 s48, s38
    s_mov_b32 s49, s39
    s_mov_b32 s50, 1792
    s_mov_b32 s51, 0x20000
    s_lshr_b32 s5, s3, 1
    s_lshl_b32 s5, s5, 4
    s_lshr_b32 s6, s4, 1
    s_add_u32 s5, s5, s6
    s_mul_i32 s78, s5, 24576
    s_add_u32 s78, s78, 131072
    s_and_b32 s6, s4, 1
    s_lshl_b32 s6, s6, 11
    s_add_u32 s56, s78, s6
    s_add_u32 s56, s56, 0
    s_add_u32 s57, s78, s6
    s_add_u32 s57, s57, 4096
    s_add_u32 s58, s78, s6
    s_add_u32 s58, s58, 8192
    s_add_u32 s59, s78, s6
    s_add_u32 s59, s59, 12288
    s_add_u32 s60, s78, s6
    s_add_u32 s60, s60, 16384
    s_add_u32 s61, s78, s6
    s_add_u32 s61, s61, 20480
    s_and_b32 s6, s3, 1
    s_lshl_b32 s6, s6, 6
    v_add_u32 v2, s6, v0
    v_lshlrev_b32 v18, 4, v2
    s_lshr_b32 s6, s3, 1
    s_mul_i32 s6, s6, 320
    v_lshlrev_b32 v20, 1, v2
    v_add_u32 v20, s6, v20
    v_lshrrev_b32 v2, 2, v0
    v_and_b32 v2, 1, v2
    v_mul_u32_u24 v21, 320, v2
    v_lshrrev_b32 v2, 4, v0
    v_lshl_add_u32 v21, v2, 4, v21
    s_lshl_b32 s77, s4, 13
    s_lshl_b32 s6, s3, 11
    s_add_u32 s77, s77, s6
    s_add_u32 s77, s77, 1048576
    s_lshr_b32 s6, s4, 1
    s_mul_i32 s6, s6, 6
    s_lshl_b32 s79, s6, 6
    s_add_u32 s79, s79, 4096
    v_mov_b32 v4, 0
    s_mov_b32 s45, 0
L_poll_27:
    buffer_load_dwordx2 v[6:7], v4, s[52:55], s79 offen sc1
    s_waitcnt vmcnt(0)
    v_xor_b32 v2, s44, v6
    v_xor_b32 v3, s44, v7
    v_or_b32 v2, v2, v3
    v_cmp_ne_u32 vcc, 0, v2
    s_nop 1
    s_cbranch_vccz L_pollok_28
    s_sleep 16
    s_add_u32 s45, s45, 1
    s_cmp_lt_u32 s45, 200000
    s_cbranch_scc1 L_poll_27
L_pollok_28:
    v_lshlrev_b32 v232, 16, v19
    v_and_b32 v233, 0xffff0000, v19
    v_lshlrev_b32 v234, 16, v22
    v_and_b32 v235, 0xffff0000, v22
    v_lshlrev_b32 v236, 16, v23
    v_and_b32 v237, 0xffff0000, v23
    s_mov_b64 s[16:17], -1
    s_mov_b64 s[18:19], -1
    s_mov_b64 s[20:21], -1
    s_mov_b64 s[22:23], -1
    s_mov_b64 s[24:25], -1
    s_mov_b64 s[26:27], -1
    s_mov_b32 s45, 0
L_mp_29:
    s_mov_b64 exec, s[16:17]
    s_cbranch_execz L_mpsk_31
    buffer_load_dwordx4 v[192:195], v18, s[52:55], s56 offen sc1
L_mpsk_31:
    s_mov_b64 exec, s[18:19]
    s_cbranch_execz L_mpsk_32
    buffer_load_dwordx4 v[196:199], v18, s[52:55], s57 offen sc1
L_mpsk_32:
    s_mov_b64 exec, s[20:21]
    s_cbranch_execz L_mpsk_33
    buffer_load_dwordx4 v[200:203], v18, s[52:55], s58 offen sc1
L_mpsk_33:
    s_mov_b64 exec, s[22:23]
    s_cbranch_execz L_mpsk_34
    buffer_load_dwordx4 v[204:207], v18, s[52:55], s59 offen sc1
L_mpsk_34:
    s_mov_b64 exec, s[24:25]
    s_cbranch_execz L_mpsk_35
    buffer_load_dwordx4 v[208:211], v18, s[52:55], s60 offen sc1
L_mpsk_35:
    s_mov_b64 exec, s[26:27]
    s_cbranch_execz L_mpsk_36
    buffer_load_dwordx4 v[212:215], v18, s[52:55], s61 offen sc1
L_mpsk_36:
    s_mov_b64 exec, -1
    s_waitcnt vmcnt(0)
    v_bitop3_b32 v4, v193, v195, s44 bitop3:0x7e
    v_bitop3_b32 v5, v197, v199, s44 bitop3:0x7e
    v_bitop3_b32 v6, v201, v203, s44 bitop3:0x7e
    v_bitop3_b32 v7, v205, v207, s44 bitop3:0x7e
    v_bitop3_b32 v8, v209, v211, s44 bitop3:0x7e
    v_bitop3_b32 v9, v213, v215, s44 bitop3:0x7e
    v_cmp_ne_u32 s[16:17], 0, v4
    v_cmp_ne_u32 s[18:19], 0, v5
    v_cmp_ne_u32 s[20:21], 0, v6
    v_cmp_ne_u32 s[22:23], 0, v7
    v_cmp_ne_u32 s[24:25], 0, v8
    v_cmp_ne_u32 s[26:27], 0, v9
    s_or_b64 s[46:47], s[16:17], s[18:19]
    s_or_b64 s[46:47], s[46:47], s[20:21]
    s_or_b64 s[46:47], s[46:47], s[22:23]
    s_or_b64 s[46:47], s[46:47], s[24:25]
    s_or_b64 s[46:47], s[46:47], s[26:27]
    s_cbranch_scc0 L_mpdone_30
    s_mov_b64 s[46:47], s[16:17]
    s_and_b64 s[46:47], s[46:47], s[18:19]
    s_and_b64 s[46:47], s[46:47], s[20:21]
    s_and_b64 s[46:47], s[46:47], s[22:23]
    s_and_b64 s[46:47], s[46:47], s[24:25]
    s_and_b64 s[46:47], s[46:47], s[26:27]
    s_cmp_eq_u32 s46, -1
    s_cbranch_scc0 L_mpbusy_37
    s_sleep 8
L_mpbusy_37:
    s_add_u32 s45, s45, 1
    s_cmp_lt_u32 s45, 200000
    s_cbranch_scc1 L_mp_29
L_mpdone_30:
    s_mov_b64 exec, -1
    v_max3_f32 v2, v194, v198, v202
    v_max3_f32 v2, v206, v210, v2
    v_max_f32 v2, v214, v2
    v_sub_f32 v194, v194, v2
    v_sub_f32 v198, v198, v2
    v_sub_f32 v202, v202, v2
    v_sub_f32 v206, v206, v2
    v_sub_f32 v210, v210, v2
    v_sub_f32 v214, v214, v2
    v_exp_f32 v194, v194
    v_exp_f32 v198, v198
    v_exp_f32 v202, v202
    v_exp_f32 v206, v206
    v_exp_f32 v210, v210
    v_exp_f32 v214, v214
    v_add_f32 v3, v194, v198
    v_mul_f32 v2, v194, v192
    v_add_f32 v4, v202, v206
    v_fmac_f32 v2, v198, v196
    v_add_f32 v5, v210, v214
    v_fmac_f32 v2, v202, v200
    v_add_f32 v3, v3, v4
    v_fmac_f32 v2, v206, v204
    v_add_f32 v3, v3, v5
    v_fmac_f32 v2, v210, v208
    v_rcp_f32 v3, v3
    v_fmac_f32 v2, v214, v212
    v_mul_f32 v2, v2, v3
    v_cvt_pk_bf16_f32 v2, v2, v2
    ds_write_b16 v20, v2 offset:4608
    s_waitcnt lgkmcnt(0)
    s_barrier
    ds_read_b128 v[4:7], v21 offset:4608
    ds_read_b128 v[8:11], v21 offset:4672
    ds_read_b128 v[12:15], v21 offset:4736
    ds_read_b128 v[216:219], v21 offset:4800
    s_waitcnt lgkmcnt(3)
    v_mfma_f32_16x16x32_bf16 v[32:35], v[4:7], v[64:67], 0
    v_mfma_f32_16x16x32_bf16 v[36:39], v[4:7], v[68:71], 0
    v_mfma_f32_16x16x32_bf16 v[40:43], v[4:7], v[72:75], 0
    v_mfma_f32_16x16x32_bf16 v[44:47], v[4:7], v[76:79], 0
    v_mfma_f32_16x16x32_bf16 v[48:51], v[4:7], v[80:83], 0
    v_mfma_f32_16x16x32_bf16 v[52:55], v[4:7], v[84:87], 0
    v_mfma_f32_16x16x32_bf16 v[56:59], v[4:7], v[88:91], 0
    v_mfma_f32_16x16x32_bf16 v[60:63], v[4:7], v[92:95], 0
    s_waitcnt lgkmcnt(2)
    v_mfma_f32_16x16x32_bf16 v[32:35], v[8:11], v[96:99], v[32:35]
    v_mfma_f32_16x16x32_bf16 v[36:39], v[8:11], v[100:103], v[36:39]
    v_mfma_f32_16x16x32_bf16 v[40:43], v[8:11], v[104:107], v[40:43]
    v_mfma_f32_16x16x32_bf16 v[44:47], v[8:11], v[108:111], v[44:47]
    v_mfma_f32_16x16x32_bf16 v[48:51], v[8:11], v[112:115], v[48:51]
    v_mfma_f32_16x16x32_bf16 v[52:55], v[8:11], v[116:119], v[52:55]
    v_mfma_f32_16x16x32_bf16 v[56:59], v[8:11], v[120:123], v[56:59]
    v_mfma_f32_16x16x32_bf16 v[60:63], v[8:11], v[124:127], v[60:63]
    s_waitcnt lgkmcnt(1)
    v_mfma_f32_16x16x32_bf16 v[32:35], v[12:15], v[128:131], v[32:35]
    v_mfma_f32_16x16x32_bf16 v[36:39], v[12:15], v[132:135], v[36:39]
    v_mfma_f32_16x16x32_bf16 v[40:43], v[12:15], v[136:139], v[40:43]
    v_mfma_f32_16x16x32_bf16 v[44:47], v[12:15], v[140:143], v[44:47]
    v_mfma_f32_16x16x32_bf16 v[48:51], v[12:15], v[144:147], v[48:51]
    v_mfma_f32_16x16x32_bf16 v[52:55], v[12:15], v[148:151], v[52:55]
    v_mfma_f32_16x16x32_bf16 v[56:59], v[12:15], v[152:155], v[56:59]
    v_mfma_f32_16x16x32_bf16 v[60:63], v[12:15], v[156:159], v[60:63]
    s_waitcnt lgkmcnt(0)
    v_mfma_f32_16x16x32_bf16 v[32:35], v[216:219], v[160:163], v[32:35]
    v_mfma_f32_16x16x32_bf16 v[36:39], v[216:219], v[164:167], v[36:39]
    v_mfma_f32_16x16x32_bf16 v[40:43], v[216:219], v[168:171], v[40:43]
    v_mfma_f32_16x16x32_bf16 v[44:47], v[216:219], v[172:175], v[44:47]
    v_mfma_f32_16x16x32_bf16 v[48:51], v[216:219], v[176:179], v[48:51]
    v_mfma_f32_16x16x32_bf16 v[52:55], v[216:219], v[180:183], v[52:55]
    v_mfma_f32_16x16x32_bf16 v[56:59], v[216:219], v[184:187], v[56:59]
    v_mfma_f32_16x16x32_bf16 v[60:63], v[216:219], v[188:191], v[60:63]
    s_mov_b32 exec_lo, -1
    s_mov_b32 exec_hi, 0
    s_nop 5
    v_mov_b32 v34, v36
    v_mov_b32 v33, s44
    v_mov_b32 v35, s44
    buffer_store_dwordx4 v[32:35], v16, s[52:55], s77 offen offset:0 sc1
    v_mov_b32 v42, v44
    v_mov_b32 v41, s44
    v_mov_b32 v43, s44
    buffer_store_dwordx4 v[40:43], v16, s[52:55], s77 offen offset:512 sc1
    v_mov_b32 v50, v52
    v_mov_b32 v49, s44
    v_mov_b32 v51, s44
    buffer_store_dwordx4 v[48:51], v16, s[52:55], s77 offen offset:1024 sc1
    v_mov_b32 v58, v60
    v_mov_b32 v57, s44
    v_mov_b32 v59, s44
    buffer_store_dwordx4 v[56:59], v16, s[52:55], s77 offen offset:1536 sc1
    s_mov_b64 exec, -1
    v_lshrrev_b32 v2, 4, v0
    v_lshlrev_b32 v25, 15, v2
    v_and_b32 v2, 15, v0
    v_lshl_add_u32 v25, v2, 4, v25
    v_lshlrev_b32 v22, 3, v2
    s_lshl_b32 s5, s3, 7
    v_add_u32 v19, s5, v22
    v_lshlrev_b32 v27, 3, v0
    v_lshlrev_b32 v24, 1, v26
    s_lshl_b32 s77, s4, 7
    s_add_u32 s77, s77, 73728
    s_lshl_b32 s79, s4, 8
    s_lshl_b32 s5, s3, 13
    s_add_u32 s79, s79, s5
    s_add_u32 s56, s79, 1048576
    s_add_u32 s57, s56, 131072
    s_mov_b64 s[16:17], -1
    s_mov_b64 s[18:19], -1
    s_mov_b32 s45, 0
L_mp_38:
    s_mov_b64 exec, s[16:17]
    s_cbranch_execz L_mpsk_40
    buffer_load_dwordx4 v[64:67], v25, s[52:55], s56 offen sc1
L_mpsk_40:
    s_mov_b64 exec, s[18:19]
    s_cbranch_execz L_mpsk_41
    buffer_load_dwordx4 v[68:71], v25, s[52:55], s57 offen sc1
L_mpsk_41:
    s_mov_b64 exec, -1
    s_waitcnt vmcnt(0)
    v_bitop3_b32 v4, v65, v67, s44 bitop3:0x7e
    v_bitop3_b32 v5, v69, v71, s44 bitop3:0x7e
    v_cmp_ne_u32 s[16:17], 0, v4
    v_cmp_ne_u32 s[18:19], 0, v5
    s_or_b64 s[46:47], s[16:17], s[18:19]
    s_cbranch_scc0 L_mpdone_39
    s_mov_b64 s[46:47], s[16:17]
    s_and_b64 s[46:47], s[46:47], s[18:19]
    s_cmp_eq_u32 s46, -1
    s_cbranch_scc0 L_mpbusy_42
    s_sleep 8
L_mpbusy_42:
    s_add_u32 s45, s45, 1
    s_cmp_lt_u32 s45, 200000
    s_cbranch_scc1 L_mp_38
L_mpdone_39:
    s_mov_b64 exec, -1
    v_add_f32 v64, v64, v68
    v_add_f32 v66, v66, v70
    v_mov_b32 v65, v64
    v_mov_b32 v67, v66
    s_nop 1
    v_permlane16_swap_b32 v64, v65
    v_permlane16_swap_b32 v66, v67
    s_nop 0
    v_add_f32 v64, v64, v65
    v_add_f32 v66, v66, v67
    v_mov_b32 v65, v64
    v_mov_b32 v67, v66
    s_nop 1
    v_permlane32_swap_b32 v64, v65
    v_permlane32_swap_b32 v66, v67
    s_nop 0
    v_add_f32 v64, v64, v65
    v_add_f32 v66, v66, v67
    v_mov_b32 v65, v66
    s_mov_b64 exec, 0xffff
    ds_write_b64 v19, v[64:65] offset:5376
    s_mov_b64 exec, -1
    s_waitcnt lgkmcnt(0)
    s_barrier
    s_cmp_lg_u32 s3, 0
    s_cbranch_scc1 L_nox2_43
    ds_read_b64 v[72:73], v22 offset:5376
    ds_read_b64 v[74:75], v22 offset:5504
    ds_read_b64 v[76:77], v22 offset:5632
    ds_read_b64 v[78:79], v22 offset:5760
    s_waitcnt lgkmcnt(0)
    v_pk_add_f32 v[72:73], v[72:73], v[74:75]
    v_pk_add_f32 v[76:77], v[76:77], v[78:79]
    v_pk_add_f32 v[72:73], v[72:73], v[76:77]
    v_mov_b32 v64, v72
    v_mov_b32 v66, v73
    v_mov_b32 v3, s44
    v_cvt_pk_bf16_f32 v2, v64, v66
    v_lshlrev_b32 v64, 16, v2
    v_and_b32 v66, 0xffff0000, v2
    v_mul_f32 v64, v64, v234
    v_mul_f32 v66, v66, v235
    v_cvt_pk_bf16_f32 v2, v64, v66
    v_lshlrev_b32 v64, 16, v2
    v_and_b32 v66, 0xffff0000, v2
    v_add_f32 v64, v64, v232
    v_add_f32 v66, v66, v233
    v_cvt_pk_bf16_f32 v2, v64, v66
    s_and_b32 exec_lo, s66, 0xffff
    s_mov_b32 exec_hi, 0
    buffer_store_dwordx2 v[2:3], v27, s[52:55], s77 offen offset:0 sc1
    s_add_u32 s77, s77, 4096
    buffer_store_dwordx2 v[2:3], v27, s[52:55], s77 offen offset:0 sc1
    s_add_u32 s77, s77, 4096
    buffer_store_dwordx2 v[2:3], v27, s[52:55], s77 offen offset:0 sc1
    s_add_u32 s77, s77, 4096
    buffer_store_dwordx2 v[2:3], v27, s[52:55], s77 offen offset:0 sc1
    s_mov_b64 exec, -1
    v_lshlrev_b32 v238, 16, v2
    v_and_b32 v239, 0xffff0000, v2
L_nox2_43:
    s_barrier
    s_mul_i32 s77, s80, 896
    s_lshl_b32 s79, s4, 8
    s_lshl_b32 s5, s3, 13
    s_add_u32 s79, s79, s5
    s_add_u32 s56, s79, 1310720
    s_add_u32 s57, s56, 131072
    s_mov_b32 exec_lo, 0
    s_mov_b32 exec_hi, 0xffff0000
    v_mov_b32 v68, 0
    v_mov_b32 v69, s44
    v_mov_b32 v70, 0
    v_mov_b32 v71, s44
    s_mov_b64 exec, -1
    s_mov_b64 s[16:17], -1
    s_mov_b32 s18, 0xffffffff
    s_mov_b32 s19, 0xffff
    s_mov_b32 s45, 0
L_mp_44:
    s_mov_b64 exec, s[16:17]
    s_cbranch_execz L_mpsk_46
    buffer_load_dwordx4 v[64:67], v25, s[52:55], s56 offen sc1
L_mpsk_46:
    s_mov_b64 exec, s[18:19]
    s_cbranch_execz L_mpsk_47
    buffer_load_dwordx4 v[68:71], v25, s[52:55], s57 offen sc1
L_mpsk_47:
    s_mov_b64 exec, -1
    s_waitcnt vmcnt(0)
    v_bitop3_b32 v4, v65, v67, s44 bitop3:0x7e
    v_bitop3_b32 v5, v69, v71, s44 bitop3:0x7e
    v_cmp_ne_u32 s[16:17], 0, v4
    v_cmp_ne_u32 s[18:19], 0, v5
    s_or_b64 s[46:47], s[16:17], s[18:19]
    s_cbranch_scc0 L_mpdone_45
    s_mov_b64 s[46:47], s[16:17]
    s_and_b64 s[46:47], s[46:47], s[18:19]
    s_cmp_eq_u32 s46, -1
    s_cbranch_scc0 L_mpbusy_48
    s_sleep 8
L_mpbusy_48:
    s_add_u32 s45, s45, 1
    s_cmp_lt_u32 s45, 200000
    s_cbranch_scc1 L_mp_44
L_mpdone_45:
    s_mov_b64 exec, -1
    v_add_f32 v64, v64, v68
    v_add_f32 v66, v66, v70
    v_mov_b32 v65, v64
    v_mov_b32 v67, v66
    s_nop 1
    v_permlane16_swap_b32 v64, v65
    v_permlane16_swap_b32 v66, v67
    s_nop 0
    v_add_f32 v64, v64, v65
    v_add_f32 v66, v66, v67
    v_mov_b32 v65, v64
    v_mov_b32 v67, v66
    s_nop 1
    v_permlane32_swap_b32 v64, v65
    v_permlane32_swap_b32 v66, v67
    s_nop 0
    v_add_f32 v64, v64, v65
    v_add_f32 v66, v66, v67
    v_mov_b32 v65, v66
    s_mov_b64 exec, 0xffff
    ds_write_b64 v19, v[64:65] offset:5376
    s_mov_b64 exec, -1
    s_waitcnt lgkmcnt(0)
    s_barrier
    s_cmp_lg_u32 s3, 0
    s_cbranch_scc1 L_exit
    ds_read_b64 v[72:73], v22 offset:5376
    ds_read_b64 v[74:75], v22 offset:5504
    ds_read_b64 v[76:77], v22 offset:5632
    ds_read_b64 v[78:79], v22 offset:5760
    s_waitcnt lgkmcnt(0)
    v_pk_add_f32 v[72:73], v[72:73], v[74:75]
    v_pk_add_f32 v[76:77], v[76:77], v[78:79]
    v_pk_add_f32 v[72:73], v[72:73], v[76:77]
    v_mov_b32 v64, v72
    v_mov_b32 v66, v73
    v_cvt_pk_bf16_f32 v2, v64, v66
    v_lshlrev_b32 v64, 16, v2
    v_and_b32 v66, 0xffff0000, v2
    v_mul_f32 v64, v64, v236
    v_mul_f32 v66, v66, v237
    v_cvt_pk_bf16_f32 v2, v64, v66
    v_lshlrev_b32 v64, 16, v2
    v_and_b32 v66, 0xffff0000, v2
    v_add_f32 v64, v64, v238
    v_add_f32 v66, v66, v239
    v_cvt_pk_bf16_f32 v2, v64, v66
    s_and_b32 exec_lo, s66, 0xffff
    s_mov_b32 exec_hi, 0
    buffer_store_dword v2, v24, s[48:51], s77 offen sc0 sc1
    s_cmp_lg_u32 s4, 0
    s_cbranch_scc1 L_exit
    s_mov_b64 exec, 1
    v_mov_b32 v5, s44
    v_mov_b32 v6, 0
    buffer_store_dword v5, v6, s[52:55], 0 offen sc1
    s_endpgm
L_rf:
    s_sub_u32 s78, s4, 32
    s_cmp_ge_u32 s78, 28
    s_cbranch_scc1 L_exit
    v_lshrrev_b32 v2, 4, v0
    v_lshlrev_b32 v2, 3, v2
    s_lshl_b32 s5, s3, 5
    v_add_u32 v2, s5, v2
    v_mul_u32_u24 v17, 3584, v2
    v_and_b32 v2, 7, v0
    v_lshl_add_u32 v17, v2, 4, v17
    s_lshl_b32 s7, s78, 7
    s_sub_u32 s75, 1605632, s7
    s_add_u32 s8, s28, s7
    s_addc_u32 s9, s29, 0
    s_mov_b32 s10, s75
    s_mov_b32 s11, 0x20000
    s_add_u32 s12, s30, s7
    s_addc_u32 s13, s31, 0
    s_mov_b32 s14, s75
    s_mov_b32 s15, 0x20000
    s_mul_i32 s7, s78, 57344
    s_sub_u32 s75, 1605632, s7
    s_add_u32 s48, s32, s7
    s_addc_u32 s49, s33, 0
    s_mov_b32 s50, s75
    s_mov_b32 s51, 0x20000
    v_lshrrev_b32 v2, 4, v0
    v_mul_u32_u24 v18, 7168, v2
    v_and_b32 v2, 15, v0
    v_lshl_add_u32 v18, v2, 4, v18
    s_lshl_b32 s5, s3, 8
    v_add_u32 v18, s5, v18
    s_cmp_ge_u32 s3, 2
    s_cbranch_scc1 L_nosb_49
    s_mul_i32 s77, s74, 10752
    s_add_u32 s77, s77, 21760
    s_mov_b32 exec_lo, -1
    s_mov_b32 exec_hi, 0x00ffffff
    s_mov_b32 s45, 0
L_poll_50:
    buffer_load_dwordx4 v[208:211], v24, s[52:55], s77 offen offset:0 sc1
    buffer_load_dwordx4 v[212:215], v24, s[52:55], s77 offen offset:16 sc1
    buffer_load_dwordx4 v[216:219], v24, s[52:55], s77 offen offset:1792 sc1
    buffer_load_dwordx4 v[220:223], v24, s[52:55], s77 offen offset:1808 sc1
    s_waitcnt vmcnt(0)
    v_xor_b32 v2, s44, v209
    v_xor_b32 v3, s44, v211
    v_or_b32 v2, v2, v3
    v_xor_b32 v3, s44, v213
    v_or_b32 v2, v2, v3
    v_xor_b32 v3, s44, v215
    v_or_b32 v2, v2, v3
    v_xor_b32 v3, s44, v217
    v_or_b32 v2, v2, v3
    v_xor_b32 v3, s44, v219
    v_or_b32 v2, v2, v3
    v_xor_b32 v3, s44, v221
    v_or_b32 v2, v2, v3
    v_xor_b32 v3, s44, v223
    v_or_b32 v2, v2, v3
    v_cmp_ne_u32 vcc, 0, v2
    s_nop 1
    s_cbranch_vccz L_pollok_51
    s_sleep 1
    s_add_u32 s45, s45, 1
    s_cmp_lt_u32 s45, 200000
    s_cbranch_scc1 L_poll_50
L_pollok_51:
    v_lshlrev_b32 v176, 16, v208
    v_and_b32 v177, 0xffff0000, v208
    v_lshlrev_b32 v178, 16, v210
    v_and_b32 v179, 0xffff0000, v210
    v_lshlrev_b32 v180, 16, v212
    v_and_b32 v181, 0xffff0000, v212
    v_lshlrev_b32 v182, 16, v214
    v_and_b32 v183, 0xffff0000, v214
    v_lshlrev_b32 v184, 16, v216
    v_and_b32 v185, 0xffff0000, v216
    v_lshlrev_b32 v186, 16, v218
    v_and_b32 v187, 0xffff0000, v218
    v_lshlrev_b32 v188, 16, v220
    v_and_b32 v189, 0xffff0000, v220
    v_lshlrev_b32 v190, 16, v222
    v_and_b32 v191, 0xffff0000, v222
    v_add_f32 v184, 1.0, v184
    v_add_f32 v185, 1.0, v185
    v_add_f32 v186, 1.0, v186
    v_add_f32 v187, 1.0, v187
    v_add_f32 v188, 1.0, v188
    v_add_f32 v189, 1.0, v189
    v_add_f32 v190, 1.0, v190
    v_add_f32 v191, 1.0, v191
    v_cvt_pk_bf16_f32 v2, v184, v185
    v_lshlrev_b32 v184, 16, v2
    v_and_b32 v185, 0xffff0000, v2
    v_cvt_pk_bf16_f32 v2, v186, v187
    v_lshlrev_b32 v186, 16, v2
    v_and_b32 v187, 0xffff0000, v2
    v_cvt_pk_bf16_f32 v2, v188, v189
    v_lshlrev_b32 v188, 16, v2
    v_and_b32 v189, 0xffff0000, v2
    v_cvt_pk_bf16_f32 v2, v190, v191
    v_lshlrev_b32 v190, 16, v2
    v_and_b32 v191, 0xffff0000, v2
    s_mov_b64 exec, -1
L_nosb_49:
    s_mul_i32 s5, s78, 6
    v_and_b32 v4, 7, v0
    v_mul_u32_u24 v4, 23, v4
    v_add_u32 v4, s5, v4
    v_subrev_u32 v5, 192, v4
    v_cmp_gt_u32 vcc, 192, v4
    s_nop 1
    v_cndmask_b32 v4, v5, v4, vcc
    v_lshlrev_b32 v4, 6, v4
    s_mov_b32 s45, 0
    s_mov_b32 s5, 4104
L_lw_52:
    buffer_load_dwordx2 v[6:7], v4, s[52:55], s5 offen sc1
    s_waitcnt vmcnt(0)
    v_cmp_eq_u32 vcc, s44, v6
    s_nop 1
    s_cbranch_vccnz L_lwok_53
    s_sleep 16
    s_add_u32 s45, s45, 1
    s_cmp_lt_u32 s45, 200000
    s_cbranch_scc1 L_lw_52
L_lwok_53:
    s_lshl_b32 s5, s3, 13
    s_add_u32 s5, s5, 5376
    v_add_u32 v19, s5, v16
    s_lshl_b32 s5, s3, 11
    s_add_u32 s5, s5, 5376
    v_add_u32 v22, s5, v16
    s_barrier
    s_mov_b32 exec_lo, 0x00ff00ff
    s_mov_b32 exec_hi, 0x00ff00ff
    s_mov_b32 s5, 0
    buffer_load_dwordx4 v[192:195], v17, s[8:11], s5 offen nt
    s_mov_b32 s5, 3584
    buffer_load_dwordx4 v[196:199], v17, s[8:11], s5 offen nt
    s_mov_b32 s5, 7168
    buffer_load_dwordx4 v[200:203], v17, s[8:11], s5 offen nt
    s_mov_b32 s5, 10752
    buffer_load_dwordx4 v[204:207], v17, s[8:11], s5 offen nt
    s_mov_b32 s5, 14336
    buffer_load_dwordx4 v[208:211], v17, s[8:11], s5 offen nt
    s_mov_b32 s5, 17920
    buffer_load_dwordx4 v[212:215], v17, s[8:11], s5 offen nt
    s_mov_b32 s5, 21504
    buffer_load_dwordx4 v[216:219], v17, s[8:11], s5 offen nt
    s_mov_b32 s5, 25088
    buffer_load_dwordx4 v[220:223], v17, s[8:11], s5 offen nt
    s_mov_b32 exec_lo, 0xff00ff00
    s_mov_b32 exec_hi, 0xff00ff00
    s_mov_b32 s5, 0
    buffer_load_dwordx4 v[192:195], v17, s[12:15], s5 offen nt
    s_mov_b32 s5, 3584
    buffer_load_dwordx4 v[196:199], v17, s[12:15], s5 offen nt
    s_mov_b32 s5, 7168
    buffer_load_dwordx4 v[200:203], v17, s[12:15], s5 offen nt
    s_mov_b32 s5, 10752
    buffer_load_dwordx4 v[204:207], v17, s[12:15], s5 offen nt
    s_mov_b32 s5, 14336
    buffer_load_dwordx4 v[208:211], v17, s[12:15], s5 offen nt
    s_mov_b32 s5, 17920
    buffer_load_dwordx4 v[212:215], v17, s[12:15], s5 offen nt
    s_mov_b32 s5, 21504
    buffer_load_dwordx4 v[216:219], v17, s[12:15], s5 offen nt
    s_mov_b32 s5, 25088
    buffer_load_dwordx4 v[220:223], v17, s[12:15], s5 offen nt
    s_mov_b64 exec, -1
    s_mov_b32 exec_lo, 0x00ff00ff
    s_mov_b32 exec_hi, 0x00ff00ff
    s_mov_b32 s5, 458752
    buffer_load_dwordx4 v[224:227], v17, s[8:11], s5 offen nt
    s_mov_b32 s5, 462336
    buffer_load_dwordx4 v[228:231], v17, s[8:11], s5 offen nt
    s_mov_b32 s5, 465920
    buffer_load_dwordx4 v[232:235], v17, s[8:11], s5 offen nt
    s_mov_b32 s5, 469504
    buffer_load_dwordx4 v[236:239], v17, s[8:11], s5 offen nt
    s_mov_b32 s5, 473088
    buffer_load_dwordx4 v[240:243], v17, s[8:11], s5 offen nt
    s_mov_b32 s5, 476672
    buffer_load_dwordx4 v[244:247], v17, s[8:11], s5 offen nt
    s_mov_b32 s5, 480256
    buffer_load_dwordx4 v[248:251], v17, s[8:11], s5 offen nt
    s_mov_b32 s5, 483840
    buffer_load_dwordx4 v[252:255], v17, s[8:11], s5 offen nt
    s_mov_b32 exec_lo, 0xff00ff00
    s_mov_b32 exec_hi, 0xff00ff00
    s_mov_b32 s5, 458752
    buffer_load_dwordx4 v[224:227], v17, s[12:15], s5 offen nt
    s_mov_b32 s5, 462336
    buffer_load_dwordx4 v[228:231], v17, s[12:15], s5 offen nt
    s_mov_b32 s5, 465920
    buffer_load_dwordx4 v[232:235], v17, s[12:15], s5 offen nt
    s_mov_b32 s5, 469504
    buffer_load_dwordx4 v[236:239], v17, s[12:15], s5 offen nt
    s_mov_b32 s5, 473088
    buffer_load_dwordx4 v[240:243], v17, s[12:15], s5 offen nt
    s_mov_b32 s5, 476672
    buffer_load_dwordx4 v[244:247], v17, s[12:15], s5 offen nt
    s_mov_b32 s5, 480256
    buffer_load_dwordx4 v[248:251], v17, s[12:15], s5 offen nt
    s_mov_b32 s5, 483840
    buffer_load_dwordx4 v[252:255], v17, s[12:15], s5 offen nt
    s_mov_b64 exec, -1
    s_mov_b32 exec_lo, 0x00ff00ff
    s_mov_b32 exec_hi, 0x00ff00ff
    s_mov_b32 s5, 917504
    buffer_load_dwordx4 v[128:131], v17, s[8:11], s5 offen nt
    s_mov_b32 s5, 921088
    buffer_load_dwordx4 v[132:135], v17, s[8:11], s5 offen nt
    s_mov_b32 s5, 924672
    buffer_load_dwordx4 v[136:139], v17, s[8:11], s5 offen nt
    s_mov_b32 s5, 928256
    buffer_load_dwordx4 v[140:143], v17, s[8:11], s5 offen nt
    s_mov_b32 s5, 931840
    buffer_load_dwordx4 v[144:147], v17, s[8:11], s5 offen nt
    s_mov_b32 s5, 935424
    buffer_load_dwordx4 v[148:151], v17, s[8:11], s5 offen nt
    s_mov_b32 s5, 939008
    buffer_load_dwordx4 v[152:155], v17, s[8:11], s5 offen nt
    s_mov_b32 s5, 942592
    buffer_load_dwordx4 v[156:159], v17, s[8:11], s5 offen nt
    s_mov_b32 exec_lo, 0xff00ff00
    s_mov_b32 exec_hi, 0xff00ff00
    s_mov_b32 s5, 917504
    buffer_load_dwordx4 v[128:131], v17, s[12:15], s5 offen nt
    s_mov_b32 s5, 921088
    buffer_load_dwordx4 v[132:135], v17, s[12:15], s5 offen nt
    s_mov_b32 s5, 924672
    buffer_load_dwordx4 v[136:139], v17, s[12:15], s5 offen nt
    s_mov_b32 s5, 928256
    buffer_load_dwordx4 v[140:143], v17, s[12:15], s5 offen nt
    s_mov_b32 s5, 931840
    buffer_load_dwordx4 v[144:147], v17, s[12:15], s5 offen nt
    s_mov_b32 s5, 935424
    buffer_load_dwordx4 v[148:151], v17, s[12:15], s5 offen nt
    s_mov_b32 s5, 939008
    buffer_load_dwordx4 v[152:155], v17, s[12:15], s5 offen nt
    s_mov_b32 s5, 942592
    buffer_load_dwordx4 v[156:159], v17, s[12:15], s5 offen nt
    s_mov_b64 exec, -1
    s_waitcnt vmcnt(32)
    v_perm_b32 v32, v196, v192, s64
    v_perm_b32 v33, v204, v200, s64
    v_perm_b32 v34, v212, v208, s64
    v_perm_b32 v35, v220, v216, s64
    v_perm_b32 v36, v196, v192, s65
    v_perm_b32 v37, v204, v200, s65
    v_perm_b32 v38, v212, v208, s65
    v_perm_b32 v39, v220, v216, s65
    v_perm_b32 v40, v197, v193, s64
    v_perm_b32 v41, v205, v201, s64
    v_perm_b32 v42, v213, v209, s64
    v_perm_b32 v43, v221, v217, s64
    v_perm_b32 v44, v197, v193, s65
    v_perm_b32 v45, v205, v201, s65
    v_perm_b32 v46, v213, v209, s65
    v_perm_b32 v47, v221, v217, s65
    v_perm_b32 v48, v198, v194, s64
    v_perm_b32 v49, v206, v202, s64
    v_perm_b32 v50, v214, v210, s64
    v_perm_b32 v51, v222, v218, s64
    v_perm_b32 v52, v198, v194, s65
    v_perm_b32 v53, v206, v202, s65
    v_perm_b32 v54, v214, v210, s65
    v_perm_b32 v55, v222, v218, s65
    v_perm_b32 v56, v199, v195, s64
    v_perm_b32 v57, v207, v203, s64
    v_perm_b32 v58, v215, v211, s64
    v_perm_b32 v59, v223, v219, s64
    v_perm_b32 v60, v199, v195, s65
    v_perm_b32 v61, v207, v203, s65
    v_perm_b32 v62, v215, v211, s65
    v_perm_b32 v63, v223, v219, s65
    ds_write_b128 v19, v[32:35] offset:0
    ds_write_b128 v19, v[36:39] offset:1024
    ds_write_b128 v19, v[40:43] offset:2048
    ds_write_b128 v19, v[44:47] offset:3072
    ds_write_b128 v19, v[48:51] offset:4096
    ds_write_b128 v19, v[52:55] offset:5120
    ds_write_b128 v19, v[56:59] offset:6144
    ds_write_b128 v19, v[60:63] offset:7168
    s_waitcnt lgkmcnt(0)
    s_barrier
    ds_read_b128 v[64:67], v22 offset:0
    ds_read_b128 v[68:71], v22 offset:1024
    ds_read_b128 v[72:75], v22 offset:8192
    ds_read_b128 v[76:79], v22 offset:9216
    ds_read_b128 v[80:83], v22 offset:16384
    ds_read_b128 v[84:87], v22 offset:17408
    ds_read_b128 v[88:91], v22 offset:24576
    ds_read_b128 v[92:95], v22 offset:25600
    s_waitcnt lgkmcnt(0)
    s_barrier
    s_mov_b32 exec_lo, 0x00ff00ff
    s_mov_b32 exec_hi, 0x00ff00ff
    s_mov_b32 s5, 1376256
    buffer_load_dwordx4 v[192:195], v17, s[8:11], s5 offen nt
    s_mov_b32 s5, 1379840
    buffer_load_dwordx4 v[196:199], v17, s[8:11], s5 offen nt
    s_mov_b32 s5, 1383424
    buffer_load_dwordx4 v[200:203], v17, s[8:11], s5 offen nt
    s_mov_b32 s5, 1387008
    buffer_load_dwordx4 v[204:207], v17, s[8:11], s5 offen nt
    s_mov_b32 s5, 1390592
    buffer_load_dwordx4 v[208:211], v17, s[8:11], s5 offen nt
    s_mov_b32 s5, 1394176
    buffer_load_dwordx4 v[212:215], v17, s[8:11], s5 offen nt
    s_mov_b32 s5, 1397760
    buffer_load_dwordx4 v[216:219], v17, s[8:11], s5 offen nt
    s_mov_b32 s5, 1401344
    buffer_load_dwordx4 v[220:223], v17, s[8:11], s5 offen nt
    s_mov_b32 exec_lo, 0xff00ff00
    s_mov_b32 exec_hi, 0xff00ff00
    s_mov_b32 s5, 1376256
    buffer_load_dwordx4 v[192:195], v17, s[12:15], s5 offen nt
    s_mov_b32 s5, 1379840
    buffer_load_dwordx4 v[196:199], v17, s[12:15], s5 offen nt
    s_mov_b32 s5, 1383424
    buffer_load_dwordx4 v[200:203], v17, s[12:15], s5 offen nt
    s_mov_b32 s5, 1387008
    buffer_load_dwordx4 v[204:207], v17, s[12:15], s5 offen nt
    s_mov_b32 s5, 1390592
    buffer_load_dwordx4 v[208:211], v17, s[12:15], s5 offen nt
    s_mov_b32 s5, 1394176
    buffer_load_dwordx4 v[212:215], v17, s[12:15], s5 offen nt
    s_mov_b32 s5, 1397760
    buffer_load_dwordx4 v[216:219], v17, s[12:15], s5 offen nt
    s_mov_b32 s5, 1401344
    buffer_load_dwordx4 v[220:223], v17, s[12:15], s5 offen nt
    s_mov_b64 exec, -1
    s_waitcnt vmcnt(32)
    v_perm_b32 v32, v228, v224, s64
    v_perm_b32 v33, v236, v232, s64
    v_perm_b32 v34, v244, v240, s64
    v_perm_b32 v35, v252, v248, s64
    v_perm_b32 v36, v228, v224, s65
    v_perm_b32 v37, v236, v232, s65
    v_perm_b32 v38, v244, v240, s65
    v_perm_b32 v39, v252, v248, s65
    v_perm_b32 v40, v229, v225, s64
    v_perm_b32 v41, v237, v233, s64
    v_perm_b32 v42, v245, v241, s64
    v_perm_b32 v43, v253, v249, s64
    v_perm_b32 v44, v229, v225, s65
    v_perm_b32 v45, v237, v233, s65
    v_perm_b32 v46, v245, v241, s65
    v_perm_b32 v47, v253, v249, s65
    v_perm_b32 v48, v230, v226, s64
    v_perm_b32 v49, v238, v234, s64
    v_perm_b32 v50, v246, v242, s64
    v_perm_b32 v51, v254, v250, s64
    v_perm_b32 v52, v230, v226, s65
    v_perm_b32 v53, v238, v234, s65
    v_perm_b32 v54, v246, v242, s65
    v_perm_b32 v55, v254, v250, s65
    v_perm_b32 v56, v231, v227, s64
    v_perm_b32 v57, v239, v235, s64
    v_perm_b32 v58, v247, v243, s64
    v_perm_b32 v59, v255, v251, s64
    v_perm_b32 v60, v231, v227, s65
    v_perm_b32 v61, v239, v235, s65
    v_perm_b32 v62, v247, v243, s65
    v_perm_b32 v63, v255, v251, s65
    ds_write_b128 v19, v[32:35] offset:0
    ds_write_b128 v19, v[36:39] offset:1024
    ds_write_b128 v19, v[40:43] offset:2048
    ds_write_b128 v19, v[44:47] offset:3072
    ds_write_b128 v19, v[48:51] offset:4096
    ds_write_b128 v19, v[52:55] offset:5120
    ds_write_b128 v19, v[56:59] offset:6144
    ds_write_b128 v19, v[60:63] offset:7168
    s_waitcnt lgkmcnt(0)
    s_barrier
    ds_read_b128 v[96:99], v22 offset:0
    ds_read_b128 v[100:103], v22 offset:1024
    ds_read_b128 v[104:107], v22 offset:8192
    ds_read_b128 v[108:111], v22 offset:9216
    ds_read_b128 v[112:115], v22 offset:16384
    ds_read_b128 v[116:119], v22 offset:17408
    ds_read_b128 v[120:123], v22 offset:24576
    ds_read_b128 v[124:127], v22 offset:25600
    s_waitcnt lgkmcnt(0)
    s_barrier
    s_cmp_eq_u32 s3, 3
    s_cselect_b32 exec_lo, 0x00ff00ff, -1
    s_cselect_b32 exec_hi, 0x00ff00ff, -1
    s_mov_b32 s5, 0
    buffer_load_dwordx4 v[224:227], v18, s[48:51], s5 offen nt
    s_mov_b32 s5, 896
    buffer_load_dwordx4 v[228:231], v18, s[48:51], s5 offen nt
    s_mov_b32 s5, 1792
    buffer_load_dwordx4 v[232:235], v18, s[48:51], s5 offen nt
    s_mov_b32 s5, 2688
    buffer_load_dwordx4 v[236:239], v18, s[48:51], s5 offen nt
    s_mov_b32 s5, 3584
    buffer_load_dwordx4 v[240:243], v18, s[48:51], s5 offen nt
    s_mov_b32 s5, 4480
    buffer_load_dwordx4 v[244:247], v18, s[48:51], s5 offen nt
    s_mov_b32 s5, 5376
    buffer_load_dwordx4 v[248:251], v18, s[48:51], s5 offen nt
    s_mov_b32 s5, 6272
    buffer_load_dwordx4 v[252:255], v18, s[48:51], s5 offen nt
    s_mov_b64 exec, -1
    s_waitcnt vmcnt(24)
    v_perm_b32 v32, v132, v128, s64
    v_perm_b32 v33, v140, v136, s64
    v_perm_b32 v34, v148, v144, s64
    v_perm_b32 v35, v156, v152, s64
    v_perm_b32 v36, v132, v128, s65
    v_perm_b32 v37, v140, v136, s65
    v_perm_b32 v38, v148, v144, s65
    v_perm_b32 v39, v156, v152, s65
    v_perm_b32 v40, v133, v129, s64
    v_perm_b32 v41, v141, v137, s64
    v_perm_b32 v42, v149, v145, s64
    v_perm_b32 v43, v157, v153, s64
    v_perm_b32 v44, v133, v129, s65
    v_perm_b32 v45, v141, v137, s65
    v_perm_b32 v46, v149, v145, s65
    v_perm_b32 v47, v157, v153, s65
    v_perm_b32 v48, v134, v130, s64
    v_perm_b32 v49, v142, v138, s64
    v_perm_b32 v50, v150, v146, s64
    v_perm_b32 v51, v158, v154, s64
    v_perm_b32 v52, v134, v130, s65
    v_perm_b32 v53, v142, v138, s65
    v_perm_b32 v54, v150, v146, s65
    v_perm_b32 v55, v158, v154, s65
    v_perm_b32 v56, v135, v131, s64
    v_perm_b32 v57, v143, v139, s64
    v_perm_b32 v58, v151, v147, s64
    v_perm_b32 v59, v159, v155, s64
    v_perm_b32 v60, v135, v131, s65
    v_perm_b32 v61, v143, v139, s65
    v_perm_b32 v62, v151, v147, s65
    v_perm_b32 v63, v159, v155, s65
    ds_write_b128 v19, v[32:35] offset:0
    ds_write_b128 v19, v[36:39] offset:1024
    ds_write_b128 v19, v[40:43] offset:2048
    ds_write_b128 v19, v[44:47] offset:3072
    ds_write_b128 v19, v[48:51] offset:4096
    ds_write_b128 v19, v[52:55] offset:5120
    ds_write_b128 v19, v[56:59] offset:6144
    ds_write_b128 v19, v[60:63] offset:7168
    s_waitcnt lgkmcnt(0)
    s_barrier
    ds_read_b128 v[128:131], v22 offset:0
    ds_read_b128 v[132:135], v22 offset:1024
    ds_read_b128 v[136:139], v22 offset:8192
    ds_read_b128 v[140:143], v22 offset:9216
    ds_read_b128 v[144:147], v22 offset:16384
    ds_read_b128 v[148:151], v22 offset:17408
    ds_read_b128 v[152:155], v22 offset:24576
    ds_read_b128 v[156:159], v22 offset:25600
    s_waitcnt lgkmcnt(0)
    s_barrier
    s_waitcnt vmcnt(8)
    v_perm_b32 v32, v196, v192, s64
    v_perm_b32 v33, v204, v200, s64
    v_perm_b32 v34, v212, v208, s64
    v_perm_b32 v35, v220, v216, s64
    v_perm_b32 v36, v196, v192, s65
    v_perm_b32 v37, v204, v200, s65
    v_perm_b32 v38, v212, v208, s65
    v_perm_b32 v39, v220, v216, s65
    v_perm_b32 v40, v197, v193, s64
    v_perm_b32 v41, v205, v201, s64
    v_perm_b32 v42, v213, v209, s64
    v_perm_b32 v43, v221, v217, s64
    v_perm_b32 v44, v197, v193, s65
    v_perm_b32 v45, v205, v201, s65
    v_perm_b32 v46, v213, v209, s65
    v_perm_b32 v47, v221, v217, s65
    v_perm_b32 v48, v198, v194, s64
    v_perm_b32 v49, v206, v202, s64
    v_perm_b32 v50, v214, v210, s64
    v_perm_b32 v51, v222, v218, s64
    v_perm_b32 v52, v198, v194, s65
    v_perm_b32 v53, v206, v202, s65
    v_perm_b32 v54, v214, v210, s65
    v_perm_b32 v55, v222, v218, s65
    v_perm_b32 v56, v199, v195, s64
    v_perm_b32 v57, v207, v203, s64
    v_perm_b32 v58, v215, v211, s64
    v_perm_b32 v59, v223, v219, s64
    v_perm_b32 v60, v199, v195, s65
    v_perm_b32 v61, v207, v203, s65
    v_perm_b32 v62, v215, v211, s65
    v_perm_b32 v63, v223, v219, s65
    ds_write_b128 v19, v[32:35] offset:0
    ds_write_b128 v19, v[36:39] offset:1024
    ds_write_b128 v19, v[40:43] offset:2048
    ds_write_b128 v19, v[44:47] offset:3072
    ds_write_b128 v19, v[48:51] offset:4096
    ds_write_b128 v19, v[52:55] offset:5120
    ds_write_b128 v19, v[56:59] offset:6144
    ds_write_b128 v19, v[60:63] offset:7168
    s_waitcnt lgkmcnt(0)
    s_barrier
    ds_read_b128 v[160:163], v22 offset:0
    ds_read_b128 v[164:167], v22 offset:1024
    ds_read_b128 v[168:171], v22 offset:8192
    ds_read_b128 v[172:175], v22 offset:9216
    s_waitcnt lgkmcnt(0)
    s_barrier
    s_cmp_eq_u32 s3, 3
    s_cselect_b32 exec_lo, 0x00ff00ff, -1
    s_cselect_b32 exec_hi, 0x00ff00ff, -1
    s_mov_b32 s5, 28672
    buffer_load_dwordx4 v[192:195], v18, s[48:51], s5 offen nt
    s_mov_b32 s5, 29568
    buffer_load_dwordx4 v[196:199], v18, s[48:51], s5 offen nt
    s_mov_b32 s5, 30464
    buffer_load_dwordx4 v[200:203], v18, s[48:51], s5 offen nt
    s_mov_b32 s5, 31360
    buffer_load_dwordx4 v[204:207], v18, s[48:51], s5 offen nt
    s_mov_b32 s5, 32256
    buffer_load_dwordx4 v[208:211], v18, s[48:51], s5 offen nt
    s_mov_b32 s5, 33152
    buffer_load_dwordx4 v[212:215], v18, s[48:51], s5 offen nt
    s_mov_b32 s5, 34048
    buffer_load_dwordx4 v[216:219], v18, s[48:51], s5 offen nt
    s_mov_b32 s5, 34944
    buffer_load_dwordx4 v[220:223], v18, s[48:51], s5 offen nt
    s_mov_b64 exec, -1
    s_waitcnt vmcnt(8)
    v_perm_b32 v2, v228, v224, s64
    v_accvgpr_write_b32 a0, v2
    v_perm_b32 v3, v236, v232, s64
    v_accvgpr_write_b32 a1, v3
    v_perm_b32 v2, v244, v240, s64
    v_accvgpr_write_b32 a2, v2
    v_perm_b32 v3, v252, v248, s64
    v_accvgpr_write_b32 a3, v3
    v_perm_b32 v2, v228, v224, s65
    v_accvgpr_write_b32 a4, v2
    v_perm_b32 v3, v236, v232, s65
    v_accvgpr_write_b32 a5, v3
    v_perm_b32 v2, v244, v240, s65
    v_accvgpr_write_b32 a6, v2
    v_perm_b32 v3, v252, v248, s65
    v_accvgpr_write_b32 a7, v3
    v_perm_b32 v2, v229, v225, s64
    v_accvgpr_write_b32 a8, v2
    v_perm_b32 v3, v237, v233, s64
    v_accvgpr_write_b32 a9, v3
    v_perm_b32 v2, v245, v241, s64
    v_accvgpr_write_b32 a10, v2
    v_perm_b32 v3, v253, v249, s64
    v_accvgpr_write_b32 a11, v3
    v_perm_b32 v2, v229, v225, s65
    v_accvgpr_write_b32 a12, v2
    v_perm_b32 v3, v237, v233, s65
    v_accvgpr_write_b32 a13, v3
    v_perm_b32 v2, v245, v241, s65
    v_accvgpr_write_b32 a14, v2
    v_perm_b32 v3, v253, v249, s65
    v_accvgpr_write_b32 a15, v3
    v_perm_b32 v2, v230, v226, s64
    v_accvgpr_write_b32 a16, v2
    v_perm_b32 v3, v238, v234, s64
    v_accvgpr_write_b32 a17, v3
    v_perm_b32 v2, v246, v242, s64
    v_accvgpr_write_b32 a18, v2
    v_perm_b32 v3, v254, v250, s64
    v_accvgpr_write_b32 a19, v3
    v_perm_b32 v2, v230, v226, s65
    v_accvgpr_write_b32 a20, v2
    v_perm_b32 v3, v238, v234, s65
    v_accvgpr_write_b32 a21, v3
    v_perm_b32 v2, v246, v242, s65
    v_accvgpr_write_b32 a22, v2
    v_perm_b32 v3, v254, v250, s65
    v_accvgpr_write_b32 a23, v3
    v_perm_b32 v2, v231, v227, s64
    v_accvgpr_write_b32 a24, v2
    v_perm_b32 v3, v239, v235, s64
    v_accvgpr_write_b32 a25, v3
    v_perm_b32 v2, v247, v243, s64
    v_accvgpr_write_b32 a26, v2
    v_perm_b32 v3, v255, v251, s64
    v_accvgpr_write_b32 a27, v3
    v_perm_b32 v2, v231, v227, s65
    v_accvgpr_write_b32 a28, v2
    v_perm_b32 v3, v239, v235, s65
    v_accvgpr_write_b32 a29, v3
    v_perm_b32 v2, v247, v243, s65
    v_accvgpr_write_b32 a30, v2
    v_perm_b32 v3, v255, v251, s65
    v_accvgpr_write_b32 a31, v3
    s_waitcnt vmcnt(0)
    v_perm_b32 v2, v196, v192, s64
    v_accvgpr_write_b32 a32, v2
    v_perm_b32 v3, v204, v200, s64
    v_accvgpr_write_b32 a33, v3
    v_perm_b32 v2, v212, v208, s64
    v_accvgpr_write_b32 a34, v2
    v_perm_b32 v3, v220, v216, s64
    v_accvgpr_write_b32 a35, v3
    v_perm_b32 v2, v196, v192, s65
    v_accvgpr_write_b32 a36, v2
    v_perm_b32 v3, v204, v200, s65
    v_accvgpr_write_b32 a37, v3
    v_perm_b32 v2, v212, v208, s65
    v_accvgpr_write_b32 a38, v2
    v_perm_b32 v3, v220, v216, s65
    v_accvgpr_write_b32 a39, v3
    v_perm_b32 v2, v197, v193, s64
    v_accvgpr_write_b32 a40, v2
    v_perm_b32 v3, v205, v201, s64
    v_accvgpr_write_b32 a41, v3
    v_perm_b32 v2, v213, v209, s64
    v_accvgpr_write_b32 a42, v2
    v_perm_b32 v3, v221, v217, s64
    v_accvgpr_write_b32 a43, v3
    v_perm_b32 v2, v197, v193, s65
    v_accvgpr_write_b32 a44, v2
    v_perm_b32 v3, v205, v201, s65
    v_accvgpr_write_b32 a45, v3
    v_perm_b32 v2, v213, v209, s65
    v_accvgpr_write_b32 a46, v2
    v_perm_b32 v3, v221, v217, s65
    v_accvgpr_write_b32 a47, v3
    v_perm_b32 v2, v198, v194, s64
    v_accvgpr_write_b32 a48, v2
    v_perm_b32 v3, v206, v202, s64
    v_accvgpr_write_b32 a49, v3
    v_perm_b32 v2, v214, v210, s64
    v_accvgpr_write_b32 a50, v2
    v_perm_b32 v3, v222, v218, s64
    v_accvgpr_write_b32 a51, v3
    v_perm_b32 v2, v198, v194, s65
    v_accvgpr_write_b32 a52, v2
    v_perm_b32 v3, v206, v202, s65
    v_accvgpr_write_b32 a53, v3
    v_perm_b32 v2, v214, v210, s65
    v_accvgpr_write_b32 a54, v2
    v_perm_b32 v3, v222, v218, s65
    v_accvgpr_write_b32 a55, v3
    v_perm_b32 v2, v199, v195, s64
    v_accvgpr_write_b32 a56, v2
    v_perm_b32 v3, v207, v203, s64
    v_accvgpr_write_b32 a57, v3
    v_perm_b32 v2, v215, v211, s64
    v_accvgpr_write_b32 a58, v2
    v_perm_b32 v3, v223, v219, s64
    v_accvgpr_write_b32 a59, v3
    v_perm_b32 v2, v199, v195, s65
    v_accvgpr_write_b32 a60, v2
    v_perm_b32 v3, v207, v203, s65
    v_accvgpr_write_b32 a61, v3
    v_perm_b32 v2, v215, v211, s65
    v_accvgpr_write_b32 a62, v2
    v_perm_b32 v3, v223, v219, s65
    v_accvgpr_write_b32 a63, v3
    v_lshrrev_b32 v2, 2, v0
    v_and_b32 v2, 1, v2
    v_mul_u32_u24 v17, 1152, v2
    v_lshrrev_b32 v2, 4, v0
    v_lshl_add_u32 v17, v2, 4, v17
    v_lshrrev_b32 v2, 2, v0
    v_and_b32 v2, 1, v2
    v_mul_u32_u24 v18, 320, v2
    v_lshrrev_b32 v2, 4, v0
    v_lshl_add_u32 v18, v2, 4, v18
    v_lshrrev_b32 v2, 4, v0
    v_mul_u32_u24 v19, 320, v2
    v_and_b32 v2, 7, v0
    v_lshl_add_u32 v19, v2, 4, v19
    s_lshl_b32 s5, s3, 2
    v_add_u32 v19, s5, v19
    s_lshl_b32 s77, s78, 13
    s_lshl_b32 s6, s3, 11
    s_add_u32 s77, s77, s6
    s_add_u32 s77, s77, 1310720
    s_and_b32 s79, s78, 3
    s_lshl_b32 s79, s79, 12
    s_lshl_b32 s5, s74, 7
    s_add_u32 s79, s79, s5
    s_add_u32 s79, s79, 73728
    v_lshrrev_b32 v4, 4, v0
    v_lshlrev_b32 v4, 10, v4
    v_and_b32 v5, 15, v0
    v_lshl_add_u32 v27, v5, 3, v4
    s_mov_b32 s82, -1
    s_mov_b32 s83, 0x00ffffff
    s_cmp_ge_u32 s3, 2
    s_cbranch_scc1 L_noln2_54
    s_mov_b32 exec_lo, -1
    s_mov_b32 exec_hi, 0x00ffffff
    s_mov_b64 s[16:17], s[82:83]
    s_mov_b64 s[18:19], s[82:83]
    s_mov_b64 s[20:21], s[82:83]
    s_mov_b64 s[22:23], s[82:83]
    s_mov_b32 s45, 0
L_mp_55:
    s_mov_b64 exec, s[16:17]
    s_cbranch_execz L_mpsk_57
    buffer_load_dwordx2 v[208:209], v27, s[52:55], s79 offen offset:0 sc1
L_mpsk_57:
    s_mov_b64 exec, s[18:19]
    s_cbranch_execz L_mpsk_58
    buffer_load_dwordx2 v[210:211], v27, s[52:55], s79 offen offset:256 sc1
L_mpsk_58:
    s_mov_b64 exec, s[20:21]
    s_cbranch_execz L_mpsk_59
    buffer_load_dwordx2 v[212:213], v27, s[52:55], s79 offen offset:512 sc1
L_mpsk_59:
    s_mov_b64 exec, s[22:23]
    s_cbranch_execz L_mpsk_60
    buffer_load_dwordx2 v[214:215], v27, s[52:55], s79 offen offset:768 sc1
L_mpsk_60:
    s_mov_b64 exec, s[82:83]
    s_waitcnt vmcnt(0)
    v_cmp_ne_u32 s[16:17], s44, v209
    v_cmp_ne_u32 s[18:19], s44, v211
    v_cmp_ne_u32 s[20:21], s44, v213
    v_cmp_ne_u32 s[22:23], s44, v215
    s_or_b64 s[46:47], s[16:17], s[18:19]
    s_or_b64 s[46:47], s[46:47], s[20:21]
    s_or_b64 s[46:47], s[46:47], s[22:23]
    s_cbranch_scc0 L_mpdone_56
    s_mov_b64 s[46:47], s[16:17]
    s_and_b64 s[46:47], s[46:47], s[18:19]
    s_and_b64 s[46:47], s[46:47], s[20:21]
    s_and_b64 s[46:47], s[46:47], s[22:23]
    s_cmp_eq_u32 s46, -1
    s_cbranch_scc0 L_mpbusy_61
    s_sleep 8
L_mpbusy_61:
    s_add_u32 s45, s45, 1
    s_cmp_lt_u32 s45, 200000
    s_cbranch_scc1 L_mp_55
L_mpdone_56:
    s_mov_b64 exec, s[82:83]
    s_mov_b64 exec, -1
    v_lshlrev_b32 v216, 16, v208
    v_and_b32 v217, 0xffff0000, v208
    v_lshlrev_b32 v218, 16, v210
    v_and_b32 v219, 0xffff0000, v210
    v_lshlrev_b32 v220, 16, v212
    v_and_b32 v221, 0xffff0000, v212
    v_lshlrev_b32 v222, 16, v214
    v_and_b32 v223, 0xffff0000, v214
    v_readfirstlane_b32 s7, v216
    v_cmp_gt_u32 vcc, 56, v0
    s_nop 0
    v_mov_b32 v8, s7
    v_pk_add_f32 v[224:225], v[216:217], v[8:9] op_sel_hi:[1,0] neg_lo:[0,1] neg_hi:[0,1]
    v_pk_add_f32 v[226:227], v[218:219], v[8:9] op_sel_hi:[1,0] neg_lo:[0,1] neg_hi:[0,1]
    v_pk_add_f32 v[228:229], v[220:221], v[8:9] op_sel_hi:[1,0] neg_lo:[0,1] neg_hi:[0,1]
    v_pk_add_f32 v[230:231], v[222:223], v[8:9] op_sel_hi:[1,0] neg_lo:[0,1] neg_hi:[0,1]
    v_pk_add_f32 v[2:3], v[224:225], v[226:227]
    v_pk_mul_f32 v[4:5], v[224:225], v[224:225]
    v_pk_add_f32 v[6:7], v[228:229], v[230:231]
    v_pk_fma_f32 v[4:5], v[226:227], v[226:227], v[4:5]
    v_pk_add_f32 v[2:3], v[2:3], v[6:7]
    v_pk_fma_f32 v[4:5], v[228:229], v[228:229], v[4:5]
    v_add_f32 v2, v2, v3
    v_pk_fma_f32 v[4:5], v[230:231], v[230:231], v[4:5]
    v_cndmask_b32 v2, 0, v2, vcc
    v_add_f32 v4, v4, v5
    v_cndmask_b32 v4, 0, v4, vcc
    s_nop 0
    v_add_f32_dpp v2, v2, v2 row_shr:1 row_mask:0xf bank_mask:0xf bound_ctrl:0
    v_add_f32_dpp v4, v4, v4 row_shr:1 row_mask:0xf bank_mask:0xf bound_ctrl:0
    s_nop 0
    v_add_f32_dpp v2, v2, v2 row_shr:2 row_mask:0xf bank_mask:0xf bound_ctrl:0
    v_add_f32_dpp v4, v4, v4 row_shr:2 row_mask:0xf bank_mask:0xf bound_ctrl:0
    s_nop 0
    v_add_f32_dpp v2, v2, v2 row_shr:4 row_mask:0xf bank_mask:0xf bound_ctrl:0
    v_add_f32_dpp v4, v4, v4 row_shr:4 row_mask:0xf bank_mask:0xf bound_ctrl:0
    s_nop 0
    v_add_f32_dpp v2, v2, v2 row_shr:8 row_mask:0xf bank_mask:0xf bound_ctrl:0
    v_add_f32_dpp v4, v4, v4 row_shr:8 row_mask:0xf bank_mask:0xf bound_ctrl:0
    s_nop 0
    v_add_f32_dpp v2, v2, v2 row_bcast:15 row_mask:0xa bank_mask:0xf
    v_add_f32_dpp v4, v4, v4 row_bcast:15 row_mask:0xa bank_mask:0xf
    s_nop 0
    v_add_f32_dpp v2, v2, v2 row_bcast:31 row_mask:0xc bank_mask:0xf
    v_add_f32_dpp v4, v4, v4 row_bcast:31 row_mask:0xc bank_mask:0xf
    s_nop 0
    v_readlane_b32 s84, v2, 63
    v_readlane_b32 s85, v4, 63
    v_mov_b32 v6, 0x3b124925
    s_nop 0
    v_mul_f32 v2, s84, v6
    v_mul_f32 v4, s85, v6
    v_fma_f32 v4, -v2, v2, v4
    v_add_f32 v2, v2, v8
    v_max_f32 v4, 0, v4
    v_cvt_pk_bf16_f32 v6, v2, v4
    v_and_b32 v4, 0xffff0000, v6
    v_lshlrev_b32 v2, 16, v6
    v_add_f32 v4, 0x3727c5ac, v4
    v_pk_add_f32 v[224:225], v[216:217], v[2:3] op_sel_hi:[1,0] neg_lo:[0,1] neg_hi:[0,1]
    v_pk_add_f32 v[226:227], v[218:219], v[2:3] op_sel_hi:[1,0] neg_lo:[0,1] neg_hi:[0,1]
    v_cvt_pk_bf16_f32 v4, v4, v4
    v_pk_add_f32 v[228:229], v[220:221], v[2:3] op_sel_hi:[1,0] neg_lo:[0,1] neg_hi:[0,1]
    v_pk_add_f32 v[230:231], v[222:223], v[2:3] op_sel_hi:[1,0] neg_lo:[0,1] neg_hi:[0,1]
    v_lshlrev_b32 v4, 16, v4
    v_sqrt_f32 v4, v4
    v_cvt_pk_bf16_f32 v6, v224, v225
    v_lshlrev_b32 v224, 16, v6
    v_and_b32 v225, 0xffff0000, v6
    v_cvt_pk_bf16_f32 v6, v226, v227
    v_lshlrev_b32 v226, 16, v6
    v_and_b32 v227, 0xffff0000, v6
    v_cvt_pk_bf16_f32 v4, v4, v4
    v_lshlrev_b32 v4, 16, v4
    v_rcp_f32 v4, v4
    v_cvt_pk_bf16_f32 v6, v228, v229
    v_lshlrev_b32 v228, 16, v6
    v_and_b32 v229, 0xffff0000, v6
    v_cvt_pk_bf16_f32 v6, v230, v231
    v_lshlrev_b32 v230, 16, v6
    v_and_b32 v231, 0xffff0000, v6
    v_pk_mul_f32 v[224:225], v[224:225], v[4:5] op_sel_hi:[1,0]
    v_pk_mul_f32 v[226:227], v[226:227], v[4:5] op_sel_hi:[1,0]
    v_pk_mul_f32 v[228:229], v[228:229], v[4:5] op_sel_hi:[1,0]
    v_pk_mul_f32 v[230:231], v[230:231], v[4:5] op_sel_hi:[1,0]
    v_cvt_pk_bf16_f32 v6, v224, v225
    v_lshlrev_b32 v224, 16, v6
    v_and_b32 v225, 0xffff0000, v6
    v_cvt_pk_bf16_f32 v6, v226, v227
    v_lshlrev_b32 v226, 16, v6
    v_and_b32 v227, 0xffff0000, v6
    v_cvt_pk_bf16_f32 v6, v228, v229
    v_lshlrev_b32 v228, 16, v6
    v_and_b32 v229, 0xffff0000, v6
    v_cvt_pk_bf16_f32 v6, v230, v231
    v_lshlrev_b32 v230, 16, v6
    v_and_b32 v231, 0xffff0000, v6
    s_mov_b32 exec_lo, -1
    s_mov_b32 exec_hi, 0x00ffffff
    v_pk_mul_f32 v[224:225], v[224:225], v[184:185]
    v_pk_mul_f32 v[226:227], v[226:227], v[186:187]
    v_pk_mul_f32 v[228:229], v[228:229], v[188:189]
    v_pk_mul_f32 v[230:231], v[230:231], v[190:191]
    v_cvt_pk_bf16_f32 v2, v224, v225
    v_lshlrev_b32 v224, 16, v2
    v_and_b32 v225, 0xffff0000, v2
    v_cvt_pk_bf16_f32 v2, v226, v227
    v_lshlrev_b32 v226, 16, v2
    v_and_b32 v227, 0xffff0000, v2
    v_cvt_pk_bf16_f32 v2, v228, v229
    v_lshlrev_b32 v228, 16, v2
    v_and_b32 v229, 0xffff0000, v2
    v_cvt_pk_bf16_f32 v2, v230, v231
    v_lshlrev_b32 v230, 16, v2
    v_and_b32 v231, 0xffff0000, v2
    v_pk_add_f32 v[224:225], v[224:225], v[176:177]
    v_pk_add_f32 v[226:227], v[226:227], v[178:179]
    v_pk_add_f32 v[228:229], v[228:229], v[180:181]
    v_pk_add_f32 v[230:231], v[230:231], v[182:183]
    v_cvt_pk_bf16_f32 v2, v224, v225
    v_cvt_pk_bf16_f32 v3, v226, v227
    v_cvt_pk_bf16_f32 v4, v228, v229
    v_cvt_pk_bf16_f32 v5, v230, v231
    ds_write_b128 v23, v[2:5] offset:2304
    s_mov_b64 exec, -1
L_noln2_54:
    s_waitcnt lgkmcnt(0)
    s_barrier
    ds_read_b128 v[192:195], v17 offset:2304
    ds_read_b128 v[196:199], v17 offset:2368
    ds_read_b128 v[200:203], v17 offset:2432
    ds_read_b128 v[204:207], v17 offset:2496
    ds_read_b128 v[208:211], v17 offset:2560
    ds_read_b128 v[212:215], v17 offset:2624
    ds_read_b128 v[216:219], v17 offset:2688
    ds_read_b128 v[220:223], v17 offset:2752
    ds_read_b128 v[224:227], v17 offset:2816
    ds_read_b128 v[228:231], v17 offset:2880
    ds_read_b128 v[232:235], v17 offset:2944
    ds_read_b128 v[236:239], v17 offset:3008
    ds_read_b128 v[240:243], v17 offset:3072
    ds_read_b128 v[244:247], v17 offset:3136
    s_waitcnt lgkmcnt(13)
    v_mfma_f32_16x16x32_bf16 v[32:35], v[192:195], v[64:67], 0
    v_mfma_f32_16x16x32_bf16 v[36:39], v[192:195], v[68:71], 0
    s_waitcnt lgkmcnt(12)
    v_mfma_f32_16x16x32_bf16 v[32:35], v[196:199], v[72:75], v[32:35]
    v_mfma_f32_16x16x32_bf16 v[36:39], v[196:199], v[76:79], v[36:39]
    s_waitcnt lgkmcnt(11)
    v_mfma_f32_16x16x32_bf16 v[32:35], v[200:203], v[80:83], v[32:35]
    v_mfma_f32_16x16x32_bf16 v[36:39], v[200:203], v[84:87], v[36:39]
    s_waitcnt lgkmcnt(10)
    v_mfma_f32_16x16x32_bf16 v[32:35], v[204:207], v[88:91], v[32:35]
    v_mfma_f32_16x16x32_bf16 v[36:39], v[204:207], v[92:95], v[36:39]
    s_waitcnt lgkmcnt(9)
    v_mfma_f32_16x16x32_bf16 v[32:35], v[208:211], v[96:99], v[32:35]
    v_mfma_f32_16x16x32_bf16 v[36:39], v[208:211], v[100:103], v[36:39]
    s_waitcnt lgkmcnt(8)
    v_mfma_f32_16x16x32_bf16 v[32:35], v[212:215], v[104:107], v[32:35]
    v_mfma_f32_16x16x32_bf16 v[36:39], v[212:215], v[108:111], v[36:39]
    s_waitcnt lgkmcnt(7)
    v_mfma_f32_16x16x32_bf16 v[32:35], v[216:219], v[112:115], v[32:35]
    v_mfma_f32_16x16x32_bf16 v[36:39], v[216:219], v[116:119], v[36:39]
    s_waitcnt lgkmcnt(6)
    v_mfma_f32_16x16x32_bf16 v[32:35], v[220:223], v[120:123], v[32:35]
    v_mfma_f32_16x16x32_bf16 v[36:39], v[220:223], v[124:127], v[36:39]
    s_waitcnt lgkmcnt(5)
    v_mfma_f32_16x16x32_bf16 v[32:35], v[224:227], v[128:131], v[32:35]
    v_mfma_f32_16x16x32_bf16 v[36:39], v[224:227], v[132:135], v[36:39]
    s_waitcnt lgkmcnt(4)
    v_mfma_f32_16x16x32_bf16 v[32:35], v[228:231], v[136:139], v[32:35]
    v_mfma_f32_16x16x32_bf16 v[36:39], v[228:231], v[140:143], v[36:39]
    s_waitcnt lgkmcnt(3)
    v_mfma_f32_16x16x32_bf16 v[32:35], v[232:235], v[144:147], v[32:35]
    v_mfma_f32_16x16x32_bf16 v[36:39], v[232:235], v[148:151], v[36:39]
    s_waitcnt lgkmcnt(2)
    v_mfma_f32_16x16x32_bf16 v[32:35], v[236:239], v[152:155], v[32:35]
    v_mfma_f32_16x16x32_bf16 v[36:39], v[236:239], v[156:159], v[36:39]
    s_waitcnt lgkmcnt(1)
    v_mfma_f32_16x16x32_bf16 v[32:35], v[240:243], v[160:163], v[32:35]
    v_mfma_f32_16x16x32_bf16 v[36:39], v[240:243], v[164:167], v[36:39]
    s_waitcnt lgkmcnt(0)
    v_mfma_f32_16x16x32_bf16 v[32:35], v[244:247], v[168:171], v[32:35]
    v_mfma_f32_16x16x32_bf16 v[36:39], v[244:247], v[172:175], v[36:39]
    s_mov_b32 s5, 0xbfb8aa3b
    s_nop 6
    v_mov_b32_dpp v4, v32 row_ror:8 row_mask:0xf bank_mask:0xf
    v_mov_b32_dpp v5, v36 row_ror:8 row_mask:0xf bank_mask:0xf
    v_cvt_pk_bf16_f32 v6, v32, v36
    v_cvt_pk_bf16_f32 v7, v4, v5
    v_lshlrev_b32 v2, 16, v6
    v_and_b32 v3, 0xffff0000, v6
    v_mul_f32 v2, s5, v2
    v_mul_f32 v3, s5, v3
    v_exp_f32 v2, v2
    v_exp_f32 v3, v3
    v_lshlrev_b32 v4, 16, v7
    v_and_b32 v5, 0xffff0000, v7
    v_add_f32 v2, 1.0, v2
    v_add_f32 v3, 1.0, v3
    v_rcp_f32 v2, v2
    v_rcp_f32 v3, v3
    s_nop 0
    v_cvt_pk_bf16_f32 v6, v2, v3
    v_lshlrev_b32 v2, 16, v6
    v_and_b32 v3, 0xffff0000, v6
    v_mul_f32 v2, v2, v4
    v_mul_f32 v3, v3, v5
    v_cvt_pk_bf16_f32 v6, v2, v3
    s_mov_b32 exec_lo, 0x00ff00ff
    s_mov_b32 exec_hi, 0
    ds_write_b32 v19, v6 offset:4608
    s_mov_b64 exec, -1
    s_waitcnt lgkmcnt(0)
    s_barrier
    ds_read_b128 v[192:195], v18 offset:4608
    ds_read_b128 v[196:199], v18 offset:4672
    s_waitcnt lgkmcnt(1)
    v_mfma_f32_16x16x32_bf16 v[32:35], v[192:195], a[0:3], 0
    v_mfma_f32_16x16x32_bf16 v[36:39], v[192:195], a[4:7], 0
    v_mfma_f32_16x16x32_bf16 v[40:43], v[192:195], a[8:11], 0
    v_mfma_f32_16x16x32_bf16 v[44:47], v[192:195], a[12:15], 0
    v_mfma_f32_16x16x32_bf16 v[48:51], v[192:195], a[16:19], 0
    v_mfma_f32_16x16x32_bf16 v[52:55], v[192:195], a[20:23], 0
    v_mfma_f32_16x16x32_bf16 v[56:59], v[192:195], a[24:27], 0
    v_mfma_f32_16x16x32_bf16 v[60:63], v[192:195], a[28:31], 0
    s_waitcnt lgkmcnt(0)
    v_mfma_f32_16x16x32_bf16 v[32:35], v[196:199], a[32:35], v[32:35]
    v_mfma_f32_16x16x32_bf16 v[36:39], v[196:199], a[36:39], v[36:39]
    v_mfma_f32_16x16x32_bf16 v[40:43], v[196:199], a[40:43], v[40:43]
    v_mfma_f32_16x16x32_bf16 v[44:47], v[196:199], a[44:47], v[44:47]
    v_mfma_f32_16x16x32_bf16 v[48:51], v[196:199], a[48:51], v[48:51]
    v_mfma_f32_16x16x32_bf16 v[52:55], v[196:199], a[52:55], v[52:55]
    v_mfma_f32_16x16x32_bf16 v[56:59], v[196:199], a[56:59], v[56:59]
    v_mfma_f32_16x16x32_bf16 v[60:63], v[196:199], a[60:63], v[60:63]
    s_mov_b32 exec_lo, -1
    s_mov_b32 exec_hi, 0
    s_nop 5
    v_mov_b32 v34, v36
    v_mov_b32 v33, s44
    v_mov_b32 v35, s44
    buffer_store_dwordx4 v[32:35], v16, s[52:55], s77 offen offset:0 sc1
    v_mov_b32 v42, v44
    v_mov_b32 v41, s44
    v_mov_b32 v43, s44
    buffer_store_dwordx4 v[40:43], v16, s[52:55], s77 offen offset:512 sc1
    v_mov_b32 v50, v52
    v_mov_b32 v49, s44
    v_mov_b32 v51, s44
    buffer_store_dwordx4 v[48:51], v16, s[52:55], s77 offen offset:1024 sc1
    v_mov_b32 v58, v60
    v_mov_b32 v57, s44
    v_mov_b32 v59, s44
    buffer_store_dwordx4 v[56:59], v16, s[52:55], s77 offen offset:1536 sc1
    s_mov_b64 exec, -1
    s_endpgm
L_exit:
    s_endpgm
L_codeend:
.section .rodata,"a"
.p2align 6
.amdhsa_kernel adaLN_cond__mha_block_cached__glu_gated_glu__decode_kernel
  .amdhsa_next_free_vgpr 512
  .amdhsa_next_free_sgpr 102
  .amdhsa_accum_offset 256
  .amdhsa_group_segment_fixed_size 0
  .amdhsa_kernarg_size 112
  .amdhsa_user_sgpr_count 2
  .amdhsa_user_sgpr_kernarg_segment_ptr 1
  .amdhsa_system_sgpr_workgroup_id_x 1
  .amdhsa_float_denorm_mode_32 3
.end_amdhsa_kernel
```
